```python
import torch

def _softmax(x, axis=-1):
    return torch.softmax(x, dim=axis)
def _gelu(x):
    return torch.nn.functional.gelu(x, approximate="tanh")
def _silu(x):
    return torch.nn.functional.silu(x)
def _sigmoid(x):
    return torch.sigmoid(x)
def _layernorm(x, axis=-1, eps=1e-5):
    m = x.mean(dim=axis, keepdim=True)
    v = x.var(dim=axis, keepdim=True, unbiased=False)
    return (x - m) / torch.sqrt(v + eps)
def _scatter_add(tgt, idx, src, axis=0):
    return tgt.clone().index_add_(axis, idx, src)
def _segment_sum(src, seg, n):
    out = torch.zeros((n,) + src.shape[1:], dtype=src.dtype)
    return out.index_add_(0, seg, src)
def _pad(x, pw):
    flat = tuple(v for pair in reversed(pw) for v in pair)
    return torch.nn.functional.pad(x, flat)

kernel_name = 'concat_heads__gqa_block_cached__sliding_block_cached__decode'

def setup_inputs():

    _w = (lambda a: (lambda t: t.to(torch.bfloat16) if t.is_floating_point() else t)(torch.as_tensor(a)))
    def _A_setup():
        B, Sq, D = 2, 1, 512
        Hq, Hkv, Sk, Dh = 32, 8, 8192, 128
        assert Hq % Hkv == 0, (Hq, Hkv)
        return {
            "x": _w((lambda *s: torch.randn(*s, dtype=torch.bfloat16) * 0.8)(B, Sq, D)),
            "k_cache": _w((lambda *s: torch.randn(*s, dtype=torch.bfloat16) * 1.6)(B, Hkv, Sk, Dh)),
            "v_cache": _w((lambda *s: torch.randn(*s, dtype=torch.bfloat16) * 0.2)(B, Hkv, Sk, Dh)),
            "wq": _w((lambda *s: torch.randn(*s, dtype=torch.bfloat16) * 1.6)(D, Hq * Dh) * (D ** -0.5)),
            "wo": _w((lambda *s: torch.randn(*s, dtype=torch.bfloat16) * 0.2)(Hq * Dh, D) * ((Hq * Dh) ** -0.5)),
        }
    _A_in = _A_setup()

    def _B_setup():
        B, Sq, D = 2, 1, 512
        Hq, Hkv, Sk, Dh = 32, 8, 8192, 128
        assert Hq % Hkv == 0, (Hq, Hkv)
        return {
            "x": _w((lambda *s: torch.randn(*s, dtype=torch.bfloat16) * 0.8)(B, Sq, D)),
            "k_cache": _w((lambda *s: torch.randn(*s, dtype=torch.bfloat16) * 1.6)(B, Hkv, Sk, Dh)),
            "v_cache": _w((lambda *s: torch.randn(*s, dtype=torch.bfloat16) * 0.2)(B, Hkv, Sk, Dh)),
            "wq": _w((lambda *s: torch.randn(*s, dtype=torch.bfloat16) * 1.6)(D, Hq * Dh) * (D ** -0.5)),
            "wo": _w((lambda *s: torch.randn(*s, dtype=torch.bfloat16) * 0.2)(Hq * Dh, D) * ((Hq * Dh) ** -0.5)),
        }
    _B_in = _B_setup()

    return {
        "A_x": _A_in["x"],
        "A_k_cache": _A_in["k_cache"],
        "A_v_cache": _A_in["v_cache"],
        "A_wq": _A_in["wq"],
        "A_wo": _A_in["wo"],
        "B_x": _B_in["x"],
        "B_k_cache": _B_in["k_cache"],
        "B_v_cache": _B_in["v_cache"],
        "B_wq": _B_in["wq"],
        "B_wo": _B_in["wo"],
    }

def reference(A_x, A_k_cache, A_v_cache, A_wq, A_wo, B_x, B_k_cache, B_v_cache, B_wq, B_wo):
    def _A_ref(x, k_cache, v_cache, wq, wo):
        B, Sq, D = x.shape
        Hq, Dh = 32, 128
        Hkv = k_cache.shape[1]
        rep = Hq // Hkv
        q = (lambda x, *d: x.permute(*d))((x @ wq).reshape(B, Sq, Hq, Dh), 0, 2, 1, 3)
        k = (lambda x, n, axis: torch.repeat_interleave(x, n, dim=axis))(k_cache, rep, axis=1)
        v = (lambda x, n, axis: torch.repeat_interleave(x, n, dim=axis))(v_cache, rep, axis=1)
        scores = torch.einsum("bhqd,bhkd->bhqk", q, k) * (Dh ** -0.5)
        p = _softmax(scores, axis=-1)
        o = torch.einsum("bhqk,bhkd->bhqd", p, v)
        return (lambda x, *d: x.permute(*d))(o, 0, 2, 1, 3).reshape(B, Sq, Hq * Dh) @ wo

    def _B_ref(x, k_cache, v_cache, wq, wo):
        B, Sq, D = x.shape
        Hq, Dh = 32, 128
        Hkv, Sk = k_cache.shape[1], k_cache.shape[2]
        W = min(4096, max(256, Sk // 4))
        rep = Hq // Hkv
        q = (lambda x, *d: x.permute(*d))((x @ wq).reshape(B, Sq, Hq, Dh), 0, 2, 1, 3)
        k = (lambda x, n, axis: torch.repeat_interleave(x, n, dim=axis))(k_cache[:, :, Sk - W:, :], rep, axis=1)
        v = (lambda x, n, axis: torch.repeat_interleave(x, n, dim=axis))(v_cache[:, :, Sk - W:, :], rep, axis=1)
        scores = torch.einsum("bhqd,bhkd->bhqk", q, k) * (Dh ** -0.5)
        p = _softmax(scores, axis=-1)
        o = torch.einsum("bhqk,bhkd->bhqd", p, v)
        return (lambda x, *d: x.permute(*d))(o, 0, 2, 1, 3).reshape(B, Sq, Hq * Dh) @ wo

    a = _A_ref(A_x, A_k_cache, A_v_cache, A_wq, A_wo)
    b = _B_ref(B_x, B_k_cache, B_v_cache, B_wq, B_wo)
    return torch.concatenate([a, b], axis=-1)
```

```asm
; @launch grid=(256,1,1) block=(768,1,1) lds=26624
.amdgcn_target "amdgcn-amd-amdhsa--gfx950"
.text
.globl concat_heads__gqa_block_cached__sliding_block_cached__decode_kernel
.p2align 8
.type concat_heads__gqa_block_cached__sliding_block_cached__decode_kernel,@function
concat_heads__gqa_block_cached__sliding_block_cached__decode_kernel:
    s_cmp_ge_u32 s2, 256
    s_cbranch_scc1 L_end
    s_load_dwordx2 s[28:29], s[0:1], 96
    s_load_dwordx16 s[4:19], s[0:1], 0
    s_load_dwordx8 s[20:27], s[0:1], 64
    v_lshrrev_b32 v1, 6, v0
    v_and_b32 v2, 63, v0
    v_mov_b32 v3, 0
    v_readfirstlane_b32 s3, v1
    s_mov_b32 s56, 0x05040100
    s_mov_b32 s57, 0x07060302
    s_bfe_u32 s48, s2, 0x40003
    s_and_b32 s49, s2, 7
    s_lshr_b32 s50, s2, 7
    s_lshl_b32 s49, s49, 1
    s_add_u32 s49, s49, s50
    s_cmp_ge_u32 s3, 2
    s_cbranch_scc1 L_data
L_service:
    s_lshr_b32 s52, s2, 7
    s_bfe_u32 s53, s2, 0x10006
    s_and_b32 s54, s2, 63
    s_lshl_b32 s55, s53, 8
    s_lshl_b32 s68, s3, 7
    s_add_u32 s55, s55, s68
    s_lshl_b32 s68, s55, 13
    s_lshl_b32 s69, s54, 7
    s_add_u32 s60, s68, s69
    s_movk_i32 s58, 0x2000
    s_add_u32 s68, s60, 524288
    s_add_u32 s61, s60, s58
    s_add_u32 s69, s68, s58
    s_add_u32 s62, s61, s58
    s_add_u32 s70, s69, s58
    s_add_u32 s63, s62, s58
    s_add_u32 s71, s70, s58
    s_add_u32 s64, s63, s58
    s_add_u32 s72, s71, s58
    s_add_u32 s65, s64, s58
    s_add_u32 s73, s72, s58
    s_add_u32 s66, s65, s58
    s_add_u32 s74, s73, s58
    s_add_u32 s67, s66, s58
    s_add_u32 s75, s74, s58
    v_and_b32 v4, 7, v2
    v_lshlrev_b32 v4, 4, v4
    v_bfe_u32 v5, v2, 3, 1
    v_lshl_add_u32 v4, v5, 18, v4
    v_lshrrev_b32 v6, 4, v2
    v_lshl_add_u32 v4, v6, 16, v4
    v_and_b32 v7, 1, v2
    v_lshlrev_b32 v7, 10, v7
    v_lshl_add_u32 v7, v5, 6, v7
    v_lshl_add_u32 v7, v6, 4, v7
    s_lshl_b32 s59, s55, 1
    s_cmp_eq_u32 s52, 1
    s_waitcnt lgkmcnt(0)
    s_cselect_b32 s32, s20, s10
    s_cselect_b32 s33, s21, s11
    s_mov_b32 s34, 0x400000
    s_mov_b32 s35, 0x00020000
    s_cselect_b32 s44, s14, s4
    s_cselect_b32 s45, s15, s5
    s_mov_b32 s46, 0x800
    s_mov_b32 s47, 0x00020000
    buffer_load_dwordx4 v[136:139], v7, s[44:47], s59 offen
    buffer_load_dwordx4 v[140:143], v7, s[44:47], s59 offen offset:128
    buffer_load_dwordx4 v[8:11], v4, s[32:35], s60 offen nt
    buffer_load_dwordx4 v[12:15], v4, s[32:35], s61 offen nt
    buffer_load_dwordx4 v[16:19], v4, s[32:35], s62 offen nt
    buffer_load_dwordx4 v[20:23], v4, s[32:35], s63 offen nt
    buffer_load_dwordx4 v[24:27], v4, s[32:35], s64 offen nt
    buffer_load_dwordx4 v[28:31], v4, s[32:35], s65 offen nt
    buffer_load_dwordx4 v[32:35], v4, s[32:35], s66 offen nt
    buffer_load_dwordx4 v[36:39], v4, s[32:35], s67 offen nt
    buffer_load_dwordx4 v[40:43], v4, s[32:35], s68 offen nt
    buffer_load_dwordx4 v[44:47], v4, s[32:35], s69 offen nt
    buffer_load_dwordx4 v[48:51], v4, s[32:35], s70 offen nt
    buffer_load_dwordx4 v[52:55], v4, s[32:35], s71 offen nt
    buffer_load_dwordx4 v[56:59], v4, s[32:35], s72 offen nt
    buffer_load_dwordx4 v[60:63], v4, s[32:35], s73 offen nt
    buffer_load_dwordx4 v[64:67], v4, s[32:35], s74 offen nt
    buffer_load_dwordx4 v[68:71], v4, s[32:35], s75 offen nt
    s_barrier
    s_branch L_service2
L_data:
    v_subrev_u32 v4, 128, v0
    v_lshlrev_b32 v4, 4, v4
    v_mov_b32 v8, 0xff800000
    v_cmp_gt_u32 vcc, 32, v4
    s_mov_b32 s50, 3328
    s_nop 0
    v_cndmask_b32 v8, 0, v8, vcc
    v_cmp_gt_u32 vcc, s50, v4
    v_mov_b32 v9, v8
    v_mov_b32 v10, v8
    v_mov_b32 v11, v8
    s_and_saveexec_b64 s[50:51], vcc
    ds_write_b128 v4, v[8:11]
    s_mov_b64 exec, s[50:51]
    s_sub_u32 s54, s3, 2
    s_sub_u32 s53, s3, 7
    s_cmp_ge_u32 s3, 7
    s_cselect_b32 s54, s53, s54
    s_cselect_b32 s53, 1, 0
    s_mul_i32 s60, s48, 5
    s_add_u32 s55, s60, s54
    s_lshr_b32 s52, s55, 6
    s_lshl_b32 s55, s55, 7
    s_mul_i32 s61, s52, 2048
    s_sub_u32 s55, s55, s61
    s_sub_i32 s47, 64, s60
    s_max_i32 s47, s47, 0
    s_min_i32 s47, s47, 5
    s_sub_u32 s46, 5, s47
    s_cmp_eq_u32 s52, 1
    s_cselect_b32 s47, s46, s47
    s_lshl_b32 s60, s49, 13
    s_add_u32 s55, s55, s60
    s_lshl_b32 s60, s55, 8
    s_movk_i32 s58, 0x1000
    s_add_u32 s61, s60, s58
    s_add_u32 s62, s61, s58
    s_add_u32 s63, s62, s58
    s_add_u32 s64, s63, s58
    s_add_u32 s65, s64, s58
    s_add_u32 s66, s65, s58
    s_add_u32 s67, s66, s58
    s_waitcnt lgkmcnt(0)
    s_mov_b32 s40, s28
    s_mov_b32 s41, s29
    s_mov_b32 s42, 0x10000000
    s_mov_b32 s43, 0x00020000
    s_cmp_eq_u32 s53, 0
    s_cbranch_scc1 L_kwave
    s_barrier
    s_branch L_vwave
L_kwave:
    s_cmp_eq_u32 s52, 1
    s_cselect_b32 s32, s16, s6
    s_cselect_b32 s33, s17, s7
    s_mov_b32 s34, 0x2000000
    s_mov_b32 s35, 0x00020000
    v_and_b32 v4, 3, v2
    v_lshrrev_b32 v5, 5, v2
    v_bfe_u32 v6, v2, 2, 3
    v_lshl_add_u32 v7, v4, 2, v5
    v_lshlrev_b32 v7, 8, v7
    v_lshl_add_u32 v7, v6, 4, v7
    s_barrier
    buffer_load_dwordx4 v[8:11], v7, s[32:35], s60 offen offset:0 nt
    buffer_load_dwordx4 v[12:15], v7, s[32:35], s60 offen offset:128 nt
    buffer_load_dwordx4 v[16:19], v7, s[32:35], s60 offen offset:512 nt
    buffer_load_dwordx4 v[20:23], v7, s[32:35], s60 offen offset:640 nt
    buffer_load_dwordx4 v[24:27], v7, s[32:35], s61 offen offset:0 nt
    buffer_load_dwordx4 v[28:31], v7, s[32:35], s61 offen offset:128 nt
    buffer_load_dwordx4 v[32:35], v7, s[32:35], s61 offen offset:512 nt
    buffer_load_dwordx4 v[36:39], v7, s[32:35], s61 offen offset:640 nt
    buffer_load_dwordx4 v[40:43], v7, s[32:35], s62 offen offset:0 nt
    buffer_load_dwordx4 v[44:47], v7, s[32:35], s62 offen offset:128 nt
    buffer_load_dwordx4 v[48:51], v7, s[32:35], s62 offen offset:512 nt
    buffer_load_dwordx4 v[52:55], v7, s[32:35], s62 offen offset:640 nt
    buffer_load_dwordx4 v[56:59], v7, s[32:35], s63 offen offset:0 nt
    buffer_load_dwordx4 v[60:63], v7, s[32:35], s63 offen offset:128 nt
    buffer_load_dwordx4 v[64:67], v7, s[32:35], s63 offen offset:512 nt
    buffer_load_dwordx4 v[68:71], v7, s[32:35], s63 offen offset:640 nt
    buffer_load_dwordx4 v[72:75], v7, s[32:35], s64 offen offset:0 nt
    buffer_load_dwordx4 v[76:79], v7, s[32:35], s64 offen offset:128 nt
    buffer_load_dwordx4 v[80:83], v7, s[32:35], s64 offen offset:512 nt
    buffer_load_dwordx4 v[84:87], v7, s[32:35], s64 offen offset:640 nt
    buffer_load_dwordx4 v[88:91], v7, s[32:35], s65 offen offset:0 nt
    buffer_load_dwordx4 v[92:95], v7, s[32:35], s65 offen offset:128 nt
    buffer_load_dwordx4 v[96:99], v7, s[32:35], s65 offen offset:512 nt
    buffer_load_dwordx4 v[100:103], v7, s[32:35], s65 offen offset:640 nt
    buffer_load_dwordx4 v[104:107], v7, s[32:35], s66 offen offset:0 nt
    buffer_load_dwordx4 v[108:111], v7, s[32:35], s66 offen offset:128 nt
    buffer_load_dwordx4 v[112:115], v7, s[32:35], s66 offen offset:512 nt
    buffer_load_dwordx4 v[116:119], v7, s[32:35], s66 offen offset:640 nt
    buffer_load_dwordx4 v[120:123], v7, s[32:35], s67 offen offset:0 nt
    buffer_load_dwordx4 v[124:127], v7, s[32:35], s67 offen offset:128 nt
    buffer_load_dwordx4 v[128:131], v7, s[32:35], s67 offen offset:512 nt
    buffer_load_dwordx4 v[132:135], v7, s[32:35], s67 offen offset:640 nt
    s_mov_b32 s58, 0
spin_qp1_1:
    ds_read_b32 v1, v3 offset:124
    s_waitcnt lgkmcnt(0)
    v_readfirstlane_b32 s59, v1
    s_add_u32 s58, s58, 1
    s_cmp_ge_u32 s58, 1048576
    s_cbranch_scc1 spun_qp1_2
    s_cmp_ge_u32 s59, 1
    s_cbranch_scc1 spun_qp1_2
    s_sleep 1
    s_branch spin_qp1_1
spun_qp1_2:
    s_mov_b64 exec, 1
    v_mov_b32 v159, 1
    ds_add_u32 v3, v159 offset:120
    s_mov_b64 exec, -1
    v_lshlrev_b32 v156, 8, v4
    v_lshl_add_u32 v156, v6, 4, v156
    s_lshl_b32 s68, s52, 10
    v_add_u32 v156, s68, v156
    s_lshl_b32 s69, s52, 2
    v_mov_b32 v7, s69
    v_lshlrev_b32 v158, 2, v4
    s_lshl_b32 s68, s52, 4
    v_add_u32 v158, s68, v158
    v_bfe_u32 v152, v2, 4, 1
    v_lshl_add_u32 v152, v152, 1, v5
    v_lshl_add_u32 v152, v4, 2, v152
    v_lshlrev_b32 v157, 4, v152
    v_bfe_u32 v152, v2, 3, 1
    v_lshl_add_u32 v157, v152, 8, v157
    v_bfe_u32 v152, v2, 2, 1
    v_lshl_add_u32 v157, v152, 9, v157
    s_lshl_b32 s68, s54, 10
    v_add_u32 v157, s68, v157
    ds_read_b64 v[0:1], v3 offset:160
    s_waitcnt lgkmcnt(0)
    v_readfirstlane_b32 s30, v0
    v_readfirstlane_b32 s31, v1
    s_mov_b32 s58, 0
spin_q_3:
    ds_read_b32 v1, v7 offset:68
    s_waitcnt lgkmcnt(0)
    v_readfirstlane_b32 s59, v1
    s_add_u32 s58, s58, 1
    s_cmp_ge_u32 s58, 1048576
    s_cbranch_scc1 spun_q_4
    s_cmp_ge_u32 s59, 1
    s_cbranch_scc1 spun_q_4
    s_sleep 2
    s_branch spin_q_3
spun_q_4:
    ds_read_b128 v[136:139], v156 offset:6144
    ds_read_b128 v[140:143], v156 offset:6272
    s_waitcnt lgkmcnt(0)
    s_waitcnt vmcnt(28)
    v_mfma_f32_4x4x4_16b_bf16 v[144:147], v[8:9], v[136:137], 0
    v_mfma_f32_4x4x4_16b_bf16 v[148:151], v[16:17], v[136:137], 0
    s_nop 0
    v_mfma_f32_4x4x4_16b_bf16 v[144:147], v[10:11], v[138:139], v[144:147]
    v_mfma_f32_4x4x4_16b_bf16 v[148:151], v[18:19], v[138:139], v[148:151]
    s_nop 0
    v_mfma_f32_4x4x4_16b_bf16 v[144:147], v[12:13], v[140:141], v[144:147]
    v_mfma_f32_4x4x4_16b_bf16 v[148:151], v[20:21], v[140:141], v[148:151]
    s_nop 0
    v_mfma_f32_4x4x4_16b_bf16 v[144:147], v[14:15], v[142:143], v[144:147]
    v_mfma_f32_4x4x4_16b_bf16 v[148:151], v[22:23], v[142:143], v[148:151]
    s_nop 0
    s_waitcnt vmcnt(24)
    v_mfma_f32_4x4x4_16b_bf16 v[8:11], v[24:25], v[136:137], 0
    v_mfma_f32_4x4x4_16b_bf16 v[12:15], v[32:33], v[136:137], 0
    s_nop 0
    v_mfma_f32_4x4x4_16b_bf16 v[8:11], v[26:27], v[138:139], v[8:11]
    v_mfma_f32_4x4x4_16b_bf16 v[12:15], v[34:35], v[138:139], v[12:15]
    s_nop 0
    v_mfma_f32_4x4x4_16b_bf16 v[8:11], v[28:29], v[140:141], v[8:11]
    v_mfma_f32_4x4x4_16b_bf16 v[12:15], v[36:37], v[140:141], v[12:15]
    s_nop 0
    v_mfma_f32_4x4x4_16b_bf16 v[8:11], v[30:31], v[142:143], v[8:11]
    v_mfma_f32_4x4x4_16b_bf16 v[12:15], v[38:39], v[142:143], v[12:15]
    s_nop 0
    v_permlane16_swap_b32 v144, v148
    v_permlane16_swap_b32 v145, v149
    v_permlane16_swap_b32 v146, v150
    v_permlane16_swap_b32 v147, v151
    s_nop 0
    v_add_f32 v144, v144, v148
    v_add_f32 v145, v145, v149
    v_add_f32 v146, v146, v150
    v_add_f32 v147, v147, v151
    s_waitcnt vmcnt(20)
    v_mfma_f32_4x4x4_16b_bf16 v[24:27], v[40:41], v[136:137], 0
    v_mfma_f32_4x4x4_16b_bf16 v[28:31], v[48:49], v[136:137], 0
    s_nop 0
    v_mfma_f32_4x4x4_16b_bf16 v[24:27], v[42:43], v[138:139], v[24:27]
    v_mfma_f32_4x4x4_16b_bf16 v[28:31], v[50:51], v[138:139], v[28:31]
    s_nop 0
    v_mfma_f32_4x4x4_16b_bf16 v[24:27], v[44:45], v[140:141], v[24:27]
    v_mfma_f32_4x4x4_16b_bf16 v[28:31], v[52:53], v[140:141], v[28:31]
    s_nop 0
    v_mfma_f32_4x4x4_16b_bf16 v[24:27], v[46:47], v[142:143], v[24:27]
    v_mfma_f32_4x4x4_16b_bf16 v[28:31], v[54:55], v[142:143], v[28:31]
    s_nop 0
    v_permlane16_swap_b32 v8, v12
    v_permlane16_swap_b32 v9, v13
    v_permlane16_swap_b32 v10, v14
    v_permlane16_swap_b32 v11, v15
    s_nop 0
    v_add_f32 v8, v8, v12
    v_add_f32 v9, v9, v13
    v_add_f32 v10, v10, v14
    v_add_f32 v11, v11, v15
    s_waitcnt vmcnt(16)
    v_mfma_f32_4x4x4_16b_bf16 v[40:43], v[56:57], v[136:137], 0
    v_mfma_f32_4x4x4_16b_bf16 v[44:47], v[64:65], v[136:137], 0
    s_nop 0
    v_mfma_f32_4x4x4_16b_bf16 v[40:43], v[58:59], v[138:139], v[40:43]
    v_mfma_f32_4x4x4_16b_bf16 v[44:47], v[66:67], v[138:139], v[44:47]
    s_nop 0
    v_mfma_f32_4x4x4_16b_bf16 v[40:43], v[60:61], v[140:141], v[40:43]
    v_mfma_f32_4x4x4_16b_bf16 v[44:47], v[68:69], v[140:141], v[44:47]
    s_nop 0
    v_mfma_f32_4x4x4_16b_bf16 v[40:43], v[62:63], v[142:143], v[40:43]
    v_mfma_f32_4x4x4_16b_bf16 v[44:47], v[70:71], v[142:143], v[44:47]
    s_nop 0
    v_permlane16_swap_b32 v24, v28
    v_permlane16_swap_b32 v25, v29
    v_permlane16_swap_b32 v26, v30
    v_permlane16_swap_b32 v27, v31
    s_nop 0
    v_add_f32 v24, v24, v28
    v_add_f32 v25, v25, v29
    v_add_f32 v26, v26, v30
    v_add_f32 v27, v27, v31
    s_waitcnt vmcnt(12)
    v_mfma_f32_4x4x4_16b_bf16 v[56:59], v[72:73], v[136:137], 0
    v_mfma_f32_4x4x4_16b_bf16 v[60:63], v[80:81], v[136:137], 0
    s_nop 0
    v_mfma_f32_4x4x4_16b_bf16 v[56:59], v[74:75], v[138:139], v[56:59]
    v_mfma_f32_4x4x4_16b_bf16 v[60:63], v[82:83], v[138:139], v[60:63]
    s_nop 0
    v_mfma_f32_4x4x4_16b_bf16 v[56:59], v[76:77], v[140:141], v[56:59]
    v_mfma_f32_4x4x4_16b_bf16 v[60:63], v[84:85], v[140:141], v[60:63]
    s_nop 0
    v_mfma_f32_4x4x4_16b_bf16 v[56:59], v[78:79], v[142:143], v[56:59]
    v_mfma_f32_4x4x4_16b_bf16 v[60:63], v[86:87], v[142:143], v[60:63]
    s_nop 0
    v_permlane16_swap_b32 v40, v44
    v_permlane16_swap_b32 v41, v45
    v_permlane16_swap_b32 v42, v46
    v_permlane16_swap_b32 v43, v47
    s_nop 0
    v_add_f32 v40, v40, v44
    v_add_f32 v41, v41, v45
    v_add_f32 v42, v42, v46
    v_add_f32 v43, v43, v47
    s_waitcnt vmcnt(8)
    v_mfma_f32_4x4x4_16b_bf16 v[72:75], v[88:89], v[136:137], 0
    v_mfma_f32_4x4x4_16b_bf16 v[76:79], v[96:97], v[136:137], 0
    s_nop 0
    v_mfma_f32_4x4x4_16b_bf16 v[72:75], v[90:91], v[138:139], v[72:75]
    v_mfma_f32_4x4x4_16b_bf16 v[76:79], v[98:99], v[138:139], v[76:79]
    s_nop 0
    v_mfma_f32_4x4x4_16b_bf16 v[72:75], v[92:93], v[140:141], v[72:75]
    v_mfma_f32_4x4x4_16b_bf16 v[76:79], v[100:101], v[140:141], v[76:79]
    s_nop 0
    v_mfma_f32_4x4x4_16b_bf16 v[72:75], v[94:95], v[142:143], v[72:75]
    v_mfma_f32_4x4x4_16b_bf16 v[76:79], v[102:103], v[142:143], v[76:79]
    s_nop 0
    v_permlane16_swap_b32 v56, v60
    v_permlane16_swap_b32 v57, v61
    v_permlane16_swap_b32 v58, v62
    v_permlane16_swap_b32 v59, v63
    s_nop 0
    v_add_f32 v56, v56, v60
    v_add_f32 v57, v57, v61
    v_add_f32 v58, v58, v62
    v_add_f32 v59, v59, v63
    s_waitcnt vmcnt(4)
    v_mfma_f32_4x4x4_16b_bf16 v[88:91], v[104:105], v[136:137], 0
    v_mfma_f32_4x4x4_16b_bf16 v[92:95], v[112:113], v[136:137], 0
    s_nop 0
    v_mfma_f32_4x4x4_16b_bf16 v[88:91], v[106:107], v[138:139], v[88:91]
    v_mfma_f32_4x4x4_16b_bf16 v[92:95], v[114:115], v[138:139], v[92:95]
    s_nop 0
    v_mfma_f32_4x4x4_16b_bf16 v[88:91], v[108:109], v[140:141], v[88:91]
    v_mfma_f32_4x4x4_16b_bf16 v[92:95], v[116:117], v[140:141], v[92:95]
    s_nop 0
    v_mfma_f32_4x4x4_16b_bf16 v[88:91], v[110:111], v[142:143], v[88:91]
    v_mfma_f32_4x4x4_16b_bf16 v[92:95], v[118:119], v[142:143], v[92:95]
    s_nop 0
    v_permlane16_swap_b32 v72, v76
    v_permlane16_swap_b32 v73, v77
    v_permlane16_swap_b32 v74, v78
    v_permlane16_swap_b32 v75, v79
    s_nop 0
    v_add_f32 v72, v72, v76
    v_add_f32 v73, v73, v77
    v_add_f32 v74, v74, v78
    v_add_f32 v75, v75, v79
    s_waitcnt vmcnt(0)
    v_mfma_f32_4x4x4_16b_bf16 v[104:107], v[120:121], v[136:137], 0
    v_mfma_f32_4x4x4_16b_bf16 v[108:111], v[128:129], v[136:137], 0
    s_nop 0
    v_mfma_f32_4x4x4_16b_bf16 v[104:107], v[122:123], v[138:139], v[104:107]
    v_mfma_f32_4x4x4_16b_bf16 v[108:111], v[130:131], v[138:139], v[108:111]
    s_nop 0
    v_mfma_f32_4x4x4_16b_bf16 v[104:107], v[124:125], v[140:141], v[104:107]
    v_mfma_f32_4x4x4_16b_bf16 v[108:111], v[132:133], v[140:141], v[108:111]
    s_nop 0
    v_mfma_f32_4x4x4_16b_bf16 v[104:107], v[126:127], v[142:143], v[104:107]
    v_mfma_f32_4x4x4_16b_bf16 v[108:111], v[134:135], v[142:143], v[108:111]
    s_nop 0
    v_permlane16_swap_b32 v88, v92
    v_permlane16_swap_b32 v89, v93
    v_permlane16_swap_b32 v90, v94
    v_permlane16_swap_b32 v91, v95
    s_nop 0
    v_add_f32 v88, v88, v92
    v_add_f32 v89, v89, v93
    v_add_f32 v90, v90, v94
    v_add_f32 v91, v91, v95
    s_nop 4
    v_permlane16_swap_b32 v104, v108
    v_permlane16_swap_b32 v105, v109
    v_permlane16_swap_b32 v106, v110
    v_permlane16_swap_b32 v107, v111
    s_nop 0
    v_add_f32 v104, v104, v108
    v_add_f32 v105, v105, v109
    v_add_f32 v106, v106, v110
    v_add_f32 v107, v107, v111
    s_nop 1
    v_add_f32_dpp v148, v144, v144 row_ror:8 row_mask:0xf bank_mask:0x3
    v_add_f32_dpp v148, v24, v24 row_ror:8 row_mask:0xf bank_mask:0xc
    v_add_f32_dpp v149, v145, v145 row_ror:8 row_mask:0xf bank_mask:0x3
    v_add_f32_dpp v149, v25, v25 row_ror:8 row_mask:0xf bank_mask:0xc
    v_add_f32_dpp v150, v146, v146 row_ror:8 row_mask:0xf bank_mask:0x3
    v_add_f32_dpp v150, v26, v26 row_ror:8 row_mask:0xf bank_mask:0xc
    v_add_f32_dpp v151, v147, v147 row_ror:8 row_mask:0xf bank_mask:0x3
    v_add_f32_dpp v151, v27, v27 row_ror:8 row_mask:0xf bank_mask:0xc
    v_add_f32_dpp v12, v8, v8 row_ror:8 row_mask:0xf bank_mask:0x3
    v_add_f32_dpp v12, v40, v40 row_ror:8 row_mask:0xf bank_mask:0xc
    v_add_f32_dpp v13, v9, v9 row_ror:8 row_mask:0xf bank_mask:0x3
    v_add_f32_dpp v13, v41, v41 row_ror:8 row_mask:0xf bank_mask:0xc
    v_add_f32_dpp v14, v10, v10 row_ror:8 row_mask:0xf bank_mask:0x3
    v_add_f32_dpp v14, v42, v42 row_ror:8 row_mask:0xf bank_mask:0xc
    v_add_f32_dpp v15, v11, v11 row_ror:8 row_mask:0xf bank_mask:0x3
    v_add_f32_dpp v15, v43, v43 row_ror:8 row_mask:0xf bank_mask:0xc
    v_add_f32_dpp v60, v56, v56 row_ror:8 row_mask:0xf bank_mask:0x3
    v_add_f32_dpp v60, v88, v88 row_ror:8 row_mask:0xf bank_mask:0xc
    v_add_f32_dpp v61, v57, v57 row_ror:8 row_mask:0xf bank_mask:0x3
    v_add_f32_dpp v61, v89, v89 row_ror:8 row_mask:0xf bank_mask:0xc
    v_add_f32_dpp v62, v58, v58 row_ror:8 row_mask:0xf bank_mask:0x3
    v_add_f32_dpp v62, v90, v90 row_ror:8 row_mask:0xf bank_mask:0xc
    v_add_f32_dpp v63, v59, v59 row_ror:8 row_mask:0xf bank_mask:0x3
    v_add_f32_dpp v63, v91, v91 row_ror:8 row_mask:0xf bank_mask:0xc
    v_add_f32_dpp v76, v72, v72 row_ror:8 row_mask:0xf bank_mask:0x3
    v_add_f32_dpp v76, v104, v104 row_ror:8 row_mask:0xf bank_mask:0xc
    v_add_f32_dpp v77, v73, v73 row_ror:8 row_mask:0xf bank_mask:0x3
    v_add_f32_dpp v77, v105, v105 row_ror:8 row_mask:0xf bank_mask:0xc
    v_add_f32_dpp v78, v74, v74 row_ror:8 row_mask:0xf bank_mask:0x3
    v_add_f32_dpp v78, v106, v106 row_ror:8 row_mask:0xf bank_mask:0xc
    v_add_f32_dpp v79, v75, v75 row_ror:8 row_mask:0xf bank_mask:0x3
    v_add_f32_dpp v79, v107, v107 row_ror:8 row_mask:0xf bank_mask:0xc
    s_nop 1
    v_add_f32_dpp v128, v148, v148 row_shl:4 row_mask:0xf bank_mask:0x5
    v_add_f32_dpp v128, v60, v60 row_shr:4 row_mask:0xf bank_mask:0xa
    v_add_f32_dpp v129, v149, v149 row_shl:4 row_mask:0xf bank_mask:0x5
    v_add_f32_dpp v129, v61, v61 row_shr:4 row_mask:0xf bank_mask:0xa
    v_add_f32_dpp v130, v150, v150 row_shl:4 row_mask:0xf bank_mask:0x5
    v_add_f32_dpp v130, v62, v62 row_shr:4 row_mask:0xf bank_mask:0xa
    v_add_f32_dpp v131, v151, v151 row_shl:4 row_mask:0xf bank_mask:0x5
    v_add_f32_dpp v131, v63, v63 row_shr:4 row_mask:0xf bank_mask:0xa
    v_add_f32_dpp v132, v12, v12 row_shl:4 row_mask:0xf bank_mask:0x5
    v_add_f32_dpp v132, v76, v76 row_shr:4 row_mask:0xf bank_mask:0xa
    v_add_f32_dpp v133, v13, v13 row_shl:4 row_mask:0xf bank_mask:0x5
    v_add_f32_dpp v133, v77, v77 row_shr:4 row_mask:0xf bank_mask:0xa
    v_add_f32_dpp v134, v14, v14 row_shl:4 row_mask:0xf bank_mask:0x5
    v_add_f32_dpp v134, v78, v78 row_shr:4 row_mask:0xf bank_mask:0xa
    v_add_f32_dpp v135, v15, v15 row_shl:4 row_mask:0xf bank_mask:0x5
    v_add_f32_dpp v135, v79, v79 row_shr:4 row_mask:0xf bank_mask:0xa
    v_cvt_pk_bf16_f32 v152, v128, v129
    v_lshlrev_b32 v128, 16, v152
    v_and_b32 v129, 0xffff0000, v152
    v_mul_f32 v128, 0x3db504f3, v128
    v_mul_f32 v129, 0x3db504f3, v129
    v_cvt_pk_bf16_f32 v152, v128, v129
    v_lshlrev_b32 v128, 16, v152
    v_and_b32 v129, 0xffff0000, v152
    v_cvt_pk_bf16_f32 v152, v130, v131
    v_lshlrev_b32 v130, 16, v152
    v_and_b32 v131, 0xffff0000, v152
    v_mul_f32 v130, 0x3db504f3, v130
    v_mul_f32 v131, 0x3db504f3, v131
    v_cvt_pk_bf16_f32 v152, v130, v131
    v_lshlrev_b32 v130, 16, v152
    v_and_b32 v131, 0xffff0000, v152
    v_cvt_pk_bf16_f32 v152, v132, v133
    v_lshlrev_b32 v132, 16, v152
    v_and_b32 v133, 0xffff0000, v152
    v_mul_f32 v132, 0x3db504f3, v132
    v_mul_f32 v133, 0x3db504f3, v133
    v_cvt_pk_bf16_f32 v152, v132, v133
    v_lshlrev_b32 v132, 16, v152
    v_and_b32 v133, 0xffff0000, v152
    v_cvt_pk_bf16_f32 v152, v134, v135
    v_lshlrev_b32 v134, 16, v152
    v_and_b32 v135, 0xffff0000, v152
    v_mul_f32 v134, 0x3db504f3, v134
    v_mul_f32 v135, 0x3db504f3, v135
    v_cvt_pk_bf16_f32 v152, v134, v135
    v_lshlrev_b32 v134, 16, v152
    v_and_b32 v135, 0xffff0000, v152
    v_max3_f32 v153, v128, v129, v130
    v_max3_f32 v153, v153, v131, v132
    v_max3_f32 v153, v153, v133, v134
    v_max_f32 v153, v153, v135
    s_nop 1
    v_max_f32_dpp v153, v153, v153 row_ror:4 row_mask:0xf bank_mask:0xf
    s_nop 1
    v_max_f32_dpp v153, v153, v153 row_ror:8 row_mask:0xf bank_mask:0xf
    s_mov_b32 exec_lo, 0xf000f
    s_mov_b32 exec_hi, 0xf000f
    ds_max_f32 v158, v153 offset:0
    s_mov_b64 exec, 1
    v_mov_b32 v159, 1
    ds_add_u32 v7, v159 offset:76
    s_mov_b64 exec, -1
    s_mov_b32 s68, s47
    s_mov_b32 s58, 0
spin_mx_5:
    ds_read_b32 v1, v7 offset:76
    s_waitcnt lgkmcnt(0)
    v_readfirstlane_b32 s59, v1
    s_add_u32 s58, s58, 1
    s_cmp_ge_u32 s58, 1048576
    s_cbranch_scc1 spun_mx_6
    s_cmp_ge_u32 s59, s68
    s_cbranch_scc1 spun_mx_6
    s_sleep 1
    s_branch spin_mx_5
spun_mx_6:
    ds_read_b32 v153, v158 offset:0
    s_mov_b32 s69, 0x3fb8aa3b
    s_waitcnt lgkmcnt(0)
    v_mul_f32 v153, s69, v153
    v_fma_f32 v128, v128, s69, -v153
    v_fma_f32 v129, v129, s69, -v153
    v_fma_f32 v130, v130, s69, -v153
    v_fma_f32 v131, v131, s69, -v153
    v_fma_f32 v132, v132, s69, -v153
    v_fma_f32 v133, v133, s69, -v153
    v_fma_f32 v134, v134, s69, -v153
    v_fma_f32 v135, v135, s69, -v153
    v_exp_f32 v128, v128
    v_exp_f32 v129, v129
    v_exp_f32 v130, v130
    v_exp_f32 v131, v131
    v_exp_f32 v132, v132
    v_exp_f32 v133, v133
    v_exp_f32 v134, v134
    v_exp_f32 v135, v135
    s_nop 0
    v_add_f32 v152, v128, v129
    v_add_f32 v153, v130, v131
    v_add_f32 v152, v152, v132
    v_add_f32 v153, v153, v133
    v_add_f32 v152, v152, v134
    v_add_f32 v153, v153, v135
    v_add_f32 v152, v152, v153
    s_nop 1
    v_add_f32_dpp v152, v152, v152 row_ror:4 row_mask:0xf bank_mask:0xf
    s_nop 1
    v_add_f32_dpp v152, v152, v152 row_ror:8 row_mask:0xf bank_mask:0xf
    s_mov_b32 exec_lo, 0xf000f
    s_mov_b32 exec_hi, 0xf000f
    ds_add_f32 v158, v152 offset:32
    s_mov_b64 exec, 1
    v_mov_b32 v159, 1
    ds_add_u32 v7, v159 offset:84
    s_mov_b64 exec, -1
    s_mov_b32 s58, 0
spin_lc_7:
    ds_read_b32 v1, v7 offset:84
    s_waitcnt lgkmcnt(0)
    v_readfirstlane_b32 s59, v1
    s_add_u32 s58, s58, 1
    s_cmp_ge_u32 s58, 1048576
    s_cbranch_scc1 spun_lc_8
    s_cmp_ge_u32 s59, s68
    s_cbranch_scc1 spun_lc_8
    s_sleep 1
    s_branch spin_lc_7
spun_lc_8:
    ds_read_b32 v153, v158 offset:32
    s_waitcnt lgkmcnt(0)
    v_rcp_f32 v153, v153
    s_nop 0
    v_mul_f32 v128, v153, v128
    v_mul_f32 v129, v153, v129
    v_mul_f32 v130, v153, v130
    v_mul_f32 v131, v153, v131
    v_mul_f32 v132, v153, v132
    v_mul_f32 v133, v153, v133
    v_mul_f32 v134, v153, v134
    v_mul_f32 v135, v153, v135
    v_cvt_pk_bf16_f32 v136, v128, v129
    v_cvt_pk_bf16_f32 v137, v130, v131
    v_cvt_pk_bf16_f32 v138, v132, v133
    v_cvt_pk_bf16_f32 v139, v134, v135
    ds_write_b128 v157, v[136:139] offset:8192
    s_lshl_b32 s68, s54, 2
    v_mov_b32 v6, s68
    s_mov_b64 exec, 1
    v_mov_b32 v159, 1
    ds_add_u32 v6, v159 offset:92
    s_mov_b64 exec, -1
L_team:
    s_cmp_eq_u32 s54, 4
    s_cbranch_scc1 L_fin
    s_lshl_b32 s68, s53, 2
    v_mov_b32 v7, s68
    v_lshrrev_b32 v5, 4, v2
    v_and_b32 v167, 15, v2
    v_lshlrev_b32 v167, 4, v167
    v_lshl_add_u32 v167, v5, 11, v167
    v_and_b32 v152, 1, v2
    v_bfe_u32 v153, v2, 1, 1
    v_bfe_u32 v154, v2, 2, 2
    v_lshlrev_b32 v164, 19, v152
    v_lshl_add_u32 v164, v153, 6, v164
    v_lshl_add_u32 v164, v5, 4, v164
    v_lshlrev_b32 v163, 4, v2
    v_lshrrev_b32 v155, 3, v2
    v_mul_u32_u24 v165, 144, v155
    v_and_b32 v155, 7, v2
    v_lshl_add_u32 v165, v155, 4, v165
    v_mul_u32_u24 v166, 144, v155
    v_lshl_add_u32 v166, v5, 4, v166
    v_bfe_u32 v155, v2, 3, 1
    v_lshl_add_u32 v166, v155, 3, v166
    s_mul_i32 s68, s54, 1280
    s_add_u32 s68, s68, 21504
    v_add_u32 v166, s68, v166
    v_mov_b32 v104, 0
    v_mov_b32 v105, 0
    v_mov_b32 v106, 0
    v_mov_b32 v107, 0
    v_mov_b32 v108, 0
    v_mov_b32 v109, 0
    v_mov_b32 v110, 0
    v_mov_b32 v111, 0
    v_mov_b32 v112, 0
    v_mov_b32 v113, 0
    v_mov_b32 v114, 0
    v_mov_b32 v115, 0
    v_mov_b32 v116, 0
    v_mov_b32 v117, 0
    v_mov_b32 v118, 0
    v_mov_b32 v119, 0
    s_cmp_eq_u32 s53, 1
    s_cbranch_scc1 L_fin
    s_lshr_b32 s55, s2, 7
    s_bfe_u32 s64, s2, 0x20005
    s_and_b32 s65, s2, 7
    s_lshl_b32 s64, s64, 3
    s_add_u32 s64, s64, s65
    s_bfe_u32 s65, s2, 0x20003
    s_cmp_eq_u32 s55, 1
    s_cselect_b32 s50, s31, s30
    s_cselect_b32 s44, s22, s12
    s_cselect_b32 s45, s23, s13
    s_mov_b32 s46, 0x400000
    s_mov_b32 s47, 0x00020000
    s_lshl_b32 s72, s64, 17
    s_lshl_b32 s73, s54, 15
    s_add_u32 s72, s72, s73
    s_lshl_b32 s73, s65, 8
    s_add_u32 s72, s72, s73
    s_add_u32 s73, s72, 8192
    s_add_u32 s74, s72, 16384
    s_add_u32 s75, s72, 24576
    s_lshl_b32 s66, s55, 20
    s_lshl_b32 s67, s64, 14
    s_add_u32 s66, s66, s67
    s_lshl_b32 s67, s54, 8
    s_add_u32 s66, s66, s67
    s_add_u32 s66, s66, 0x100000
    s_mul_i32 s67, s55, 266240
    s_mul_i32 s70, s64, 8320
    s_add_u32 s67, s67, s70
    s_lshl_b32 s70, s65, 11
    s_add_u32 s67, s67, s70
    s_add_u32 s67, s67, 0x400000
    v_mov_b32 v129, s50
    v_mov_b32 v131, s50
    v_mov_b32 v133, s50
    v_mov_b32 v135, s50
    s_cmp_eq_u32 s55, 1
    s_cselect_b32 s70, 10, 12
    s_cselect_b32 s71, 12288, 0
    s_cselect_b32 s34, 0, 0x0FFF0FFF
    s_add_u32 s66, s66, s71
    v_lshlrev_b32 v154, s70, v154
    v_add_u32 v164, v154, v164
    s_mov_b64 s[32:33], -1
    s_mov_b32 s35, s34
    s_mov_b32 s36, s34
    s_mov_b32 s37, s34
    s_mov_b32 s38, s34
    s_mov_b32 s39, s34
    v_mov_b32 v16, 0
    v_mov_b32 v17, 0
    v_mov_b32 v18, 0xff7fffff
    v_mov_b32 v19, s50
    v_mov_b32 v20, 0
    v_mov_b32 v21, 0
    v_mov_b32 v22, 0xff7fffff
    v_mov_b32 v23, s50
    v_mov_b32 v24, 0
    v_mov_b32 v25, 0
    v_mov_b32 v26, 0xff7fffff
    v_mov_b32 v27, s50
    v_mov_b32 v28, 0
    v_mov_b32 v29, 0
    v_mov_b32 v30, 0xff7fffff
    v_mov_b32 v31, s50
    v_mov_b32 v32, 0
    v_mov_b32 v33, 0
    v_mov_b32 v34, 0xff7fffff
    v_mov_b32 v35, s50
    v_mov_b32 v36, 0
    v_mov_b32 v37, 0
    v_mov_b32 v38, 0xff7fffff
    v_mov_b32 v39, s50
    s_mov_b32 s58, 0
spin_vi_9:
    ds_read_b32 v1, v3 offset:128
    s_waitcnt lgkmcnt(0)
    v_readfirstlane_b32 s59, v1
    s_add_u32 s58, s58, 1
    s_cmp_ge_u32 s58, 1048576
    s_cbranch_scc1 spun_vi_10
    s_cmp_ge_u32 s59, 5
    s_cbranch_scc1 spun_vi_10
    s_sleep 2
    s_branch spin_vi_9
spun_vi_10:
    buffer_load_dwordx4 v[40:43], v167, s[44:47], s72 offen offset:0 nt
    buffer_load_dwordx4 v[44:47], v167, s[44:47], s72 offen offset:1024 nt
    buffer_load_dwordx4 v[48:51], v167, s[44:47], s73 offen offset:0 nt
    buffer_load_dwordx4 v[52:55], v167, s[44:47], s73 offen offset:1024 nt
    s_waitcnt vmcnt(0)
    buffer_load_dwordx4 v[56:59], v167, s[44:47], s74 offen offset:0 nt
    buffer_load_dwordx4 v[60:63], v167, s[44:47], s74 offen offset:1024 nt
    buffer_load_dwordx4 v[64:67], v167, s[44:47], s75 offen offset:0 nt
    buffer_load_dwordx4 v[68:71], v167, s[44:47], s75 offen offset:1024 nt
    s_waitcnt vmcnt(0)
    s_mov_b32 s58, 0
    s_mov_b64 exec, s[32:33]
    s_cbranch_execz skip_14
    buffer_load_dwordx4 v[8:11], v164, s[40:43], s66 offen offset:0 sc1
    buffer_load_dwordx4 v[12:15], v164, s[40:43], s66 offen offset:128 sc1
skip_14:
    s_mov_b64 exec, s[34:35]
    s_cbranch_execz skip_15
    buffer_load_dwordx4 v[16:19], v164, s[40:43], s66 offen offset:1024 sc1
    buffer_load_dwordx4 v[20:23], v164, s[40:43], s66 offen offset:1152 sc1
skip_15:
    s_mov_b64 exec, s[36:37]
    s_cbranch_execz skip_16
    buffer_load_dwordx4 v[24:27], v164, s[40:43], s66 offen offset:2048 sc1
    buffer_load_dwordx4 v[28:31], v164, s[40:43], s66 offen offset:2176 sc1
skip_16:
    s_mov_b64 exec, s[38:39]
    s_cbranch_execz skip_17
    buffer_load_dwordx4 v[32:35], v164, s[40:43], s66 offen offset:3072 sc1
    buffer_load_dwordx4 v[36:39], v164, s[40:43], s66 offen offset:3200 sc1
skip_17:
    s_mov_b64 exec, -1
    v_perm_b32 v72, v44, v40, s56
    v_perm_b32 v73, v52, v48, s56
    v_perm_b32 v74, v60, v56, s56
    v_perm_b32 v75, v68, v64, s56
    v_perm_b32 v76, v44, v40, s57
    v_perm_b32 v77, v52, v48, s57
    v_perm_b32 v78, v60, v56, s57
    v_perm_b32 v79, v68, v64, s57
    v_perm_b32 v80, v45, v41, s56
    v_perm_b32 v81, v53, v49, s56
    v_perm_b32 v82, v61, v57, s56
    v_perm_b32 v83, v69, v65, s56
    v_perm_b32 v84, v45, v41, s57
    v_perm_b32 v85, v53, v49, s57
    v_perm_b32 v86, v61, v57, s57
    v_perm_b32 v87, v69, v65, s57
    v_perm_b32 v88, v46, v42, s56
    v_perm_b32 v89, v54, v50, s56
    v_perm_b32 v90, v62, v58, s56
    v_perm_b32 v91, v70, v66, s56
    v_perm_b32 v92, v46, v42, s57
    v_perm_b32 v93, v54, v50, s57
    v_perm_b32 v94, v62, v58, s57
    v_perm_b32 v95, v70, v66, s57
    v_perm_b32 v96, v47, v43, s56
    v_perm_b32 v97, v55, v51, s56
    v_perm_b32 v98, v63, v59, s56
    v_perm_b32 v99, v71, v67, s56
    v_perm_b32 v100, v47, v43, s57
    v_perm_b32 v101, v55, v51, s57
    v_perm_b32 v102, v63, v59, s57
    v_perm_b32 v103, v71, v67, s57
    s_branch pchk_h2_13
poll_h2_11:
    s_mov_b64 exec, s[32:33]
    s_cbranch_execz skip_18
    buffer_load_dwordx4 v[8:11], v164, s[40:43], s66 offen offset:0 sc1
    buffer_load_dwordx4 v[12:15], v164, s[40:43], s66 offen offset:128 sc1
skip_18:
    s_mov_b64 exec, s[34:35]
    s_cbranch_execz skip_19
    buffer_load_dwordx4 v[16:19], v164, s[40:43], s66 offen offset:1024 sc1
    buffer_load_dwordx4 v[20:23], v164, s[40:43], s66 offen offset:1152 sc1
skip_19:
    s_mov_b64 exec, s[36:37]
    s_cbranch_execz skip_20
    buffer_load_dwordx4 v[24:27], v164, s[40:43], s66 offen offset:2048 sc1
    buffer_load_dwordx4 v[28:31], v164, s[40:43], s66 offen offset:2176 sc1
skip_20:
    s_mov_b64 exec, s[38:39]
    s_cbranch_execz skip_21
    buffer_load_dwordx4 v[32:35], v164, s[40:43], s66 offen offset:3072 sc1
    buffer_load_dwordx4 v[36:39], v164, s[40:43], s66 offen offset:3200 sc1
skip_21:
    s_mov_b64 exec, -1
pchk_h2_13:
    s_add_u32 s58, s58, 1
    s_waitcnt vmcnt(0)
    v_xor_b32 v6, s50, v11
    v_xor_b32 v4, s50, v15
    v_or_b32 v6, v6, v4
    v_cmp_ne_u32 s[32:33], 0, v6
    v_xor_b32 v6, s50, v19
    v_xor_b32 v4, s50, v23
    v_or_b32 v6, v6, v4
    v_cmp_ne_u32 s[34:35], 0, v6
    v_xor_b32 v6, s50, v27
    v_xor_b32 v4, s50, v31
    v_or_b32 v6, v6, v4
    v_cmp_ne_u32 s[36:37], 0, v6
    v_xor_b32 v6, s50, v35
    v_xor_b32 v4, s50, v39
    v_or_b32 v6, v6, v4
    v_cmp_ne_u32 s[38:39], 0, v6
    s_cmp_ge_u32 s58, 65536
    s_cbranch_scc1 polled_h2_12
    s_bcnt1_i32_b64 s59, s[32:33]
    s_bcnt1_i32_b64 s51, s[34:35]
    s_add_u32 s59, s59, s51
    s_bcnt1_i32_b64 s51, s[36:37]
    s_add_u32 s59, s59, s51
    s_bcnt1_i32_b64 s51, s[38:39]
    s_add_u32 s59, s59, s51
    s_cmp_eq_u32 s59, 0
    s_cbranch_scc1 polled_h2_12
    s_cmp_le_u32 s59, 16
    s_cbranch_scc1 poll_h2_11
    s_sleep 2
    s_branch poll_h2_11
polled_h2_12:
    v_max3_f32 v144, v10, v18, v26
    v_max_f32 v144, v144, v34
    s_nop 1
    v_max_f32_dpp v144, v144, v144 row_ror:4 row_mask:0xf bank_mask:0xf
    s_nop 1
    v_max_f32_dpp v144, v144, v144 row_ror:8 row_mask:0xf bank_mask:0xf
    v_sub_f32 v10, v10, v144
    v_sub_f32 v18, v18, v144
    v_sub_f32 v26, v26, v144
    v_sub_f32 v34, v34, v144
    v_exp_f32 v10, v10
    v_exp_f32 v18, v18
    v_exp_f32 v26, v26
    v_exp_f32 v34, v34
    v_mul_f32 v8, v10, v8
    v_mul_f32 v9, v10, v9
    v_mul_f32 v12, v10, v12
    v_mul_f32 v13, v10, v13
    v_add_f32 v144, v10, v18
    v_add_f32 v146, v26, v34
    v_add_f32 v144, v144, v146
    v_fmac_f32 v8, v18, v16
    v_fmac_f32 v9, v18, v17
    v_fmac_f32 v12, v18, v20
    v_fmac_f32 v13, v18, v21
    v_add_f32_dpp v144, v144, v144 row_ror:4 row_mask:0xf bank_mask:0xf
    v_fmac_f32 v8, v26, v24
    v_fmac_f32 v9, v26, v25
    v_fmac_f32 v12, v26, v28
    v_fmac_f32 v13, v26, v29
    v_add_f32_dpp v144, v144, v144 row_ror:8 row_mask:0xf bank_mask:0xf
    v_fmac_f32 v8, v34, v32
    v_fmac_f32 v9, v34, v33
    v_fmac_f32 v12, v34, v36
    v_fmac_f32 v13, v34, v37
    v_rcp_f32 v144, v144
    v_add_f32_dpp v8, v8, v8 row_ror:4 row_mask:0xf bank_mask:0xf
    v_add_f32_dpp v9, v9, v9 row_ror:4 row_mask:0xf bank_mask:0xf
    v_add_f32_dpp v12, v12, v12 row_ror:4 row_mask:0xf bank_mask:0xf
    v_add_f32_dpp v13, v13, v13 row_ror:4 row_mask:0xf bank_mask:0xf
    v_add_f32_dpp v8, v8, v8 row_ror:8 row_mask:0xf bank_mask:0xf
    v_add_f32_dpp v9, v9, v9 row_ror:8 row_mask:0xf bank_mask:0xf
    v_add_f32_dpp v12, v12, v12 row_ror:8 row_mask:0xf bank_mask:0xf
    v_add_f32_dpp v13, v13, v13 row_ror:8 row_mask:0xf bank_mask:0xf
    v_mul_f32 v8, v144, v8
    v_mul_f32 v9, v144, v9
    v_mul_f32 v12, v144, v12
    v_mul_f32 v13, v144, v13
    v_cvt_pk_bf16_f32 v146, v8, v9
    v_cvt_pk_bf16_f32 v147, v12, v13
    s_nop 0
    v_mov_b32_dpp v104, v146 quad_perm:[0,1,0,1] row_mask:0xf bank_mask:0x1
    v_mov_b32_dpp v105, v146 quad_perm:[2,3,2,3] row_mask:0xf bank_mask:0x1
    v_mov_b32_dpp v106, v147 quad_perm:[0,1,0,1] row_mask:0xf bank_mask:0x1
    v_mov_b32_dpp v107, v147 quad_perm:[2,3,2,3] row_mask:0xf bank_mask:0x1
    v_mov_b32_dpp v108, v146 quad_perm:[0,1,0,1] row_mask:0xf bank_mask:0x2
    v_mov_b32_dpp v109, v146 quad_perm:[2,3,2,3] row_mask:0xf bank_mask:0x2
    v_mov_b32_dpp v110, v147 quad_perm:[0,1,0,1] row_mask:0xf bank_mask:0x2
    v_mov_b32_dpp v111, v147 quad_perm:[2,3,2,3] row_mask:0xf bank_mask:0x2
    v_mfma_f32_16x16x32_bf16 v[120:123], v[104:107], v[72:75], 0
    v_mfma_f32_16x16x32_bf16 v[124:127], v[104:107], v[88:91], 0
    v_mov_b32_dpp v112, v146 quad_perm:[0,1,0,1] row_mask:0xf bank_mask:0x4
    v_mov_b32_dpp v113, v146 quad_perm:[2,3,2,3] row_mask:0xf bank_mask:0x4
    v_mov_b32_dpp v114, v147 quad_perm:[0,1,0,1] row_mask:0xf bank_mask:0x4
    v_mov_b32_dpp v115, v147 quad_perm:[2,3,2,3] row_mask:0xf bank_mask:0x4
    v_mfma_f32_16x16x32_bf16 v[120:123], v[108:111], v[76:79], v[120:123]
    v_mfma_f32_16x16x32_bf16 v[124:127], v[108:111], v[92:95], v[124:127]
    v_mov_b32_dpp v116, v146 quad_perm:[0,1,0,1] row_mask:0xf bank_mask:0x8
    v_mov_b32_dpp v117, v146 quad_perm:[2,3,2,3] row_mask:0xf bank_mask:0x8
    v_mov_b32_dpp v118, v147 quad_perm:[0,1,0,1] row_mask:0xf bank_mask:0x8
    v_mov_b32_dpp v119, v147 quad_perm:[2,3,2,3] row_mask:0xf bank_mask:0x8
    v_mfma_f32_16x16x32_bf16 v[120:123], v[112:115], v[80:83], v[120:123]
    v_mfma_f32_16x16x32_bf16 v[124:127], v[112:115], v[96:99], v[124:127]
    v_mfma_f32_16x16x32_bf16 v[120:123], v[116:119], v[84:87], v[120:123]
    v_mfma_f32_16x16x32_bf16 v[124:127], v[116:119], v[100:103], v[124:127]
    v_mov_b32 v148, 1
    s_nop 6
    ds_write2_b64 v166, v[120:121], v[124:125] offset0:0 offset1:8
    s_mov_b64 exec, 1
    ds_add_rtn_u32 v145, v7, v148 offset:132
    s_mov_b64 exec, -1
    ds_read_b128 v[48:51], v165 offset:21504
    ds_read_b128 v[52:55], v165 offset:22784
    ds_read_b128 v[56:59], v165 offset:24064
    ds_read_b128 v[60:63], v165 offset:25344
    s_waitcnt lgkmcnt(0)
    v_readfirstlane_b32 s72, v145
    v_add_f32 v48, v48, v52
    v_add_f32 v56, v56, v60
    v_add_f32 v49, v49, v53
    v_add_f32 v57, v57, v61
    v_add_f32 v50, v50, v54
    v_add_f32 v58, v58, v62
    v_add_f32 v51, v51, v55
    v_add_f32 v59, v59, v63
    s_cmp_lg_u32 s72, 3
    s_cbranch_scc1 L_fin
    v_add_f32 v128, v48, v56
    v_add_f32 v130, v49, v57
    buffer_store_dwordx4 v[128:131], v163, s[40:43], s67 offen sc1
    v_add_f32 v132, v50, v58
    v_add_f32 v134, v51, v59
    buffer_store_dwordx4 v[132:135], v163, s[40:43], s67 offen offset:1024 sc1
    s_waitcnt vmcnt(0)
    s_mov_b64 exec, 1
    ds_write_b32 v3, v148 offset:140
    s_mov_b64 exec, -1
    s_branch L_fin
L_vwave:
    s_cmp_eq_u32 s52, 1
    s_cselect_b32 s32, s18, s8
    s_cselect_b32 s33, s19, s9
    s_mov_b32 s34, 0x2000000
    s_mov_b32 s35, 0x00020000
    v_lshlrev_b32 v4, 4, v2
    s_mov_b32 s58, 0
spin_ki_22:
    ds_read_b32 v1, v3 offset:120
    s_waitcnt lgkmcnt(0)
    v_readfirstlane_b32 s59, v1
    s_add_u32 s58, s58, 1
    s_cmp_ge_u32 s58, 1048576
    s_cbranch_scc1 spun_ki_23
    s_cmp_ge_u32 s59, 7
    s_cbranch_scc1 spun_ki_23
    s_sleep 1
    s_branch spin_ki_22
spun_ki_23:
    buffer_load_dwordx4 v[8:11], v4, s[32:35], s60 offen offset:0 nt
    buffer_load_dwordx4 v[12:15], v4, s[32:35], s60 offen offset:1024 nt
    buffer_load_dwordx4 v[16:19], v4, s[32:35], s60 offen offset:2048 nt
    buffer_load_dwordx4 v[20:23], v4, s[32:35], s60 offen offset:3072 nt
    buffer_load_dwordx4 v[24:27], v4, s[32:35], s61 offen offset:0 nt
    buffer_load_dwordx4 v[28:31], v4, s[32:35], s61 offen offset:1024 nt
    buffer_load_dwordx4 v[32:35], v4, s[32:35], s61 offen offset:2048 nt
    buffer_load_dwordx4 v[36:39], v4, s[32:35], s61 offen offset:3072 nt
    buffer_load_dwordx4 v[40:43], v4, s[32:35], s62 offen offset:0 nt
    buffer_load_dwordx4 v[44:47], v4, s[32:35], s62 offen offset:1024 nt
    buffer_load_dwordx4 v[48:51], v4, s[32:35], s62 offen offset:2048 nt
    buffer_load_dwordx4 v[52:55], v4, s[32:35], s62 offen offset:3072 nt
    buffer_load_dwordx4 v[56:59], v4, s[32:35], s63 offen offset:0 nt
    buffer_load_dwordx4 v[60:63], v4, s[32:35], s63 offen offset:1024 nt
    buffer_load_dwordx4 v[64:67], v4, s[32:35], s63 offen offset:2048 nt
    buffer_load_dwordx4 v[68:71], v4, s[32:35], s63 offen offset:3072 nt
    buffer_load_dwordx4 v[72:75], v4, s[32:35], s64 offen offset:0 nt
    buffer_load_dwordx4 v[76:79], v4, s[32:35], s64 offen offset:1024 nt
    buffer_load_dwordx4 v[80:83], v4, s[32:35], s64 offen offset:2048 nt
    buffer_load_dwordx4 v[84:87], v4, s[32:35], s64 offen offset:3072 nt
    buffer_load_dwordx4 v[88:91], v4, s[32:35], s65 offen offset:0 nt
    buffer_load_dwordx4 v[92:95], v4, s[32:35], s65 offen offset:1024 nt
    buffer_load_dwordx4 v[96:99], v4, s[32:35], s65 offen offset:2048 nt
    buffer_load_dwordx4 v[100:103], v4, s[32:35], s65 offen offset:3072 nt
    buffer_load_dwordx4 v[104:107], v4, s[32:35], s66 offen offset:0 nt
    buffer_load_dwordx4 v[108:111], v4, s[32:35], s66 offen offset:1024 nt
    buffer_load_dwordx4 v[112:115], v4, s[32:35], s66 offen offset:2048 nt
    buffer_load_dwordx4 v[116:119], v4, s[32:35], s66 offen offset:3072 nt
    buffer_load_dwordx4 v[120:123], v4, s[32:35], s67 offen offset:0 nt
    buffer_load_dwordx4 v[124:127], v4, s[32:35], s67 offen offset:1024 nt
    buffer_load_dwordx4 v[128:131], v4, s[32:35], s67 offen offset:2048 nt
    buffer_load_dwordx4 v[132:135], v4, s[32:35], s67 offen offset:3072 nt
    s_mov_b64 exec, 1
    v_mov_b32 v1, 1
    ds_add_u32 v3, v1 offset:128
    s_mov_b64 exec, -1
    ds_read_b64 v[0:1], v3 offset:160
    s_waitcnt lgkmcnt(0)
    v_readfirstlane_b32 s30, v0
    v_readfirstlane_b32 s31, v1
    v_lshrrev_b32 v1, 4, v2
    v_and_b32 v0, 3, v2
    v_lshl_add_u32 v0, v0, 2, v1
    v_lshlrev_b32 v0, 4, v0
    s_lshl_b32 s68, s54, 10
    s_add_u32 s68, s68, 8192
    v_add_u32 v0, s68, v0
    v_mov_b32 v1, 256
    s_mov_b32 s70, 0xf000f
    s_mov_b32 s71, 0xf000f
    v_cndmask_b32 v4, v1, v0, s[70:71]
    s_mov_b32 s70, 0xf000f0
    s_mov_b32 s71, 0xf000f0
    v_cndmask_b32 v5, v1, v0, s[70:71]
    s_mov_b32 s70, 0xf000f00
    s_mov_b32 s71, 0xf000f00
    v_cndmask_b32 v6, v1, v0, s[70:71]
    s_mov_b32 s70, 0xf000f000
    s_mov_b32 s71, 0xf000f000
    v_cndmask_b32 v7, v1, v0, s[70:71]
    s_lshl_b32 s68, s54, 2
    v_mov_b32 v0, s68
    s_cmp_eq_u32 s52, 1
    s_cselect_b32 s70, s31, s30
    s_lshl_b32 s68, s52, 4
    s_add_u32 s68, s68, s49
    s_lshl_b32 s69, s68, 16
    s_lshl_b32 s72, s48, 10
    s_add_u32 s69, s69, s72
    s_add_u32 s60, s69, 0x100000
    s_add_u32 s61, s60, 16384
    s_add_u32 s62, s60, 32768
    s_add_u32 s63, s60, 49152
    s_add_u32 s64, s60, 0x800000
    s_add_u32 s65, s61, 0x800000
    s_add_u32 s66, s62, 0x800000
    s_add_u32 s67, s63, 0x800000
    s_mov_b32 s69, 0x3fb8aa3b
    s_mov_b32 s58, 0
spin_p_24:
    ds_read_b32 v1, v0 offset:92
    s_waitcnt lgkmcnt(0)
    v_readfirstlane_b32 s59, v1
    s_add_u32 s58, s58, 1
    s_cmp_ge_u32 s58, 1048576
    s_cbranch_scc1 spun_p_25
    s_cmp_ge_u32 s59, 1
    s_cbranch_scc1 spun_p_25
    s_sleep 1
    s_branch spin_p_24
spun_p_25:
    ds_read_b128 v[136:139], v4 offset:0
    ds_read_b128 v[140:143], v5 offset:0
    ds_read_b128 v[144:147], v6 offset:0
    ds_read_b128 v[148:151], v7 offset:0
    s_waitcnt vmcnt(24) lgkmcnt(0)
    v_perm_b32 v152, v12, v8, s56
    v_perm_b32 v153, v20, v16, s56
    v_perm_b32 v154, v28, v24, s56
    v_perm_b32 v155, v36, v32, s56
    s_nop 1
    v_mfma_f32_16x16x32_bf16 v[160:163], v[136:139], v[152:155], 0
    v_perm_b32 v156, v12, v8, s57
    v_perm_b32 v157, v20, v16, s57
    v_perm_b32 v158, v28, v24, s57
    v_perm_b32 v159, v36, v32, s57
    s_nop 1
    v_mfma_f32_16x16x32_bf16 v[164:167], v[136:139], v[156:159], 0
    v_perm_b32 v152, v13, v9, s56
    v_perm_b32 v153, v21, v17, s56
    v_perm_b32 v154, v29, v25, s56
    v_perm_b32 v155, v37, v33, s56
    s_nop 1
    v_mfma_f32_16x16x32_bf16 v[160:163], v[140:143], v[152:155], v[160:163]
    v_perm_b32 v156, v13, v9, s57
    v_perm_b32 v157, v21, v17, s57
    v_perm_b32 v158, v29, v25, s57
    v_perm_b32 v159, v37, v33, s57
    s_nop 1
    v_mfma_f32_16x16x32_bf16 v[164:167], v[140:143], v[156:159], v[164:167]
    v_perm_b32 v152, v14, v10, s56
    v_perm_b32 v153, v22, v18, s56
    v_perm_b32 v154, v30, v26, s56
    v_perm_b32 v155, v38, v34, s56
    s_nop 1
    v_mfma_f32_16x16x32_bf16 v[160:163], v[144:147], v[152:155], v[160:163]
    v_perm_b32 v156, v14, v10, s57
    v_perm_b32 v157, v22, v18, s57
    v_perm_b32 v158, v30, v26, s57
    v_perm_b32 v159, v38, v34, s57
    s_nop 1
    v_mfma_f32_16x16x32_bf16 v[164:167], v[144:147], v[156:159], v[164:167]
    v_perm_b32 v152, v15, v11, s56
    v_perm_b32 v153, v23, v19, s56
    v_perm_b32 v154, v31, v27, s56
    v_perm_b32 v155, v39, v35, s56
    s_nop 1
    v_mfma_f32_16x16x32_bf16 v[160:163], v[148:151], v[152:155], v[160:163]
    v_perm_b32 v156, v15, v11, s57
    v_perm_b32 v157, v23, v19, s57
    v_perm_b32 v158, v31, v27, s57
    v_perm_b32 v159, v39, v35, s57
    s_nop 1
    v_mfma_f32_16x16x32_bf16 v[164:167], v[148:151], v[156:159], v[164:167]
    ds_read_b128 v[8:11], v4 offset:256
    ds_read_b128 v[12:15], v5 offset:256
    ds_read_b128 v[16:19], v6 offset:256
    ds_read_b128 v[20:23], v7 offset:256
    ds_read_b128 v[24:27], v4 offset:512
    ds_read_b128 v[28:31], v5 offset:512
    ds_read_b128 v[32:35], v6 offset:512
    ds_read_b128 v[36:39], v7 offset:512
    s_waitcnt vmcnt(16) lgkmcnt(0)
    v_perm_b32 v152, v44, v40, s56
    v_perm_b32 v153, v52, v48, s56
    v_perm_b32 v154, v60, v56, s56
    v_perm_b32 v155, v68, v64, s56
    s_nop 1
    v_mfma_f32_16x16x32_bf16 v[160:163], v[8:11], v[152:155], v[160:163]
    v_perm_b32 v156, v44, v40, s57
    v_perm_b32 v157, v52, v48, s57
    v_perm_b32 v158, v60, v56, s57
    v_perm_b32 v159, v68, v64, s57
    s_nop 1
    v_mfma_f32_16x16x32_bf16 v[164:167], v[8:11], v[156:159], v[164:167]
    v_perm_b32 v152, v45, v41, s56
    v_perm_b32 v153, v53, v49, s56
    v_perm_b32 v154, v61, v57, s56
    v_perm_b32 v155, v69, v65, s56
    s_nop 1
    v_mfma_f32_16x16x32_bf16 v[160:163], v[12:15], v[152:155], v[160:163]
    v_perm_b32 v156, v45, v41, s57
    v_perm_b32 v157, v53, v49, s57
    v_perm_b32 v158, v61, v57, s57
    v_perm_b32 v159, v69, v65, s57
    s_nop 1
    v_mfma_f32_16x16x32_bf16 v[164:167], v[12:15], v[156:159], v[164:167]
    v_perm_b32 v152, v46, v42, s56
    v_perm_b32 v153, v54, v50, s56
    v_perm_b32 v154, v62, v58, s56
    v_perm_b32 v155, v70, v66, s56
    s_nop 1
    v_mfma_f32_16x16x32_bf16 v[160:163], v[16:19], v[152:155], v[160:163]
    v_perm_b32 v156, v46, v42, s57
    v_perm_b32 v157, v54, v50, s57
    v_perm_b32 v158, v62, v58, s57
    v_perm_b32 v159, v70, v66, s57
    s_nop 1
    v_mfma_f32_16x16x32_bf16 v[164:167], v[16:19], v[156:159], v[164:167]
    v_perm_b32 v152, v47, v43, s56
    v_perm_b32 v153, v55, v51, s56
    v_perm_b32 v154, v63, v59, s56
    v_perm_b32 v155, v71, v67, s56
    s_nop 1
    v_mfma_f32_16x16x32_bf16 v[160:163], v[20:23], v[152:155], v[160:163]
    v_perm_b32 v156, v47, v43, s57
    v_perm_b32 v157, v55, v51, s57
    v_perm_b32 v158, v63, v59, s57
    v_perm_b32 v159, v71, v67, s57
    s_nop 1
    v_mfma_f32_16x16x32_bf16 v[164:167], v[20:23], v[156:159], v[164:167]
    ds_read_b128 v[40:43], v4 offset:768
    ds_read_b128 v[44:47], v5 offset:768
    ds_read_b128 v[48:51], v6 offset:768
    ds_read_b128 v[52:55], v7 offset:768
    s_waitcnt vmcnt(8) lgkmcnt(0)
    v_perm_b32 v152, v76, v72, s56
    v_perm_b32 v153, v84, v80, s56
    v_perm_b32 v154, v92, v88, s56
    v_perm_b32 v155, v100, v96, s56
    s_nop 1
    v_mfma_f32_16x16x32_bf16 v[160:163], v[24:27], v[152:155], v[160:163]
    v_perm_b32 v156, v76, v72, s57
    v_perm_b32 v157, v84, v80, s57
    v_perm_b32 v158, v92, v88, s57
    v_perm_b32 v159, v100, v96, s57
    s_nop 1
    v_mfma_f32_16x16x32_bf16 v[164:167], v[24:27], v[156:159], v[164:167]
    v_perm_b32 v152, v77, v73, s56
    v_perm_b32 v153, v85, v81, s56
    v_perm_b32 v154, v93, v89, s56
    v_perm_b32 v155, v101, v97, s56
    s_nop 1
    v_mfma_f32_16x16x32_bf16 v[160:163], v[28:31], v[152:155], v[160:163]
    v_perm_b32 v156, v77, v73, s57
    v_perm_b32 v157, v85, v81, s57
    v_perm_b32 v158, v93, v89, s57
    v_perm_b32 v159, v101, v97, s57
    s_nop 1
    v_mfma_f32_16x16x32_bf16 v[164:167], v[28:31], v[156:159], v[164:167]
    v_perm_b32 v152, v78, v74, s56
    v_perm_b32 v153, v86, v82, s56
    v_perm_b32 v154, v94, v90, s56
    v_perm_b32 v155, v102, v98, s56
    s_nop 1
    v_mfma_f32_16x16x32_bf16 v[160:163], v[32:35], v[152:155], v[160:163]
    v_perm_b32 v156, v78, v74, s57
    v_perm_b32 v157, v86, v82, s57
    v_perm_b32 v158, v94, v90, s57
    v_perm_b32 v159, v102, v98, s57
    s_nop 1
    v_mfma_f32_16x16x32_bf16 v[164:167], v[32:35], v[156:159], v[164:167]
    v_perm_b32 v152, v79, v75, s56
    v_perm_b32 v153, v87, v83, s56
    v_perm_b32 v154, v95, v91, s56
    v_perm_b32 v155, v103, v99, s56
    s_nop 1
    v_mfma_f32_16x16x32_bf16 v[160:163], v[36:39], v[152:155], v[160:163]
    v_perm_b32 v156, v79, v75, s57
    v_perm_b32 v157, v87, v83, s57
    v_perm_b32 v158, v95, v91, s57
    v_perm_b32 v159, v103, v99, s57
    s_nop 1
    v_mfma_f32_16x16x32_bf16 v[164:167], v[36:39], v[156:159], v[164:167]
    v_lshlrev_b32 v136, 4, v2
    s_lshl_b32 s72, s54, 11
    s_add_u32 s72, s72, 13312
    s_cmp_eq_u32 s54, 4
    s_cselect_b32 s72, 1280, s72
    v_add_u32 v137, s72, v136
    s_sub_u32 s71, s47, 1
    v_mov_b32 v139, 1
    s_lshl_b32 s72, s52, 4
    v_mov_b32 v140, s72
    ds_read_b128 v[144:147], v140 offset:0
    ds_read_b128 v[148:151], v140 offset:32
    v_and_b32 v141, 15, v2
    v_lshrrev_b32 v142, 4, v2
    v_lshl_add_u32 v141, v141, 2, v142
    v_lshlrev_b32 v141, 4, v141
    s_waitcnt lgkmcnt(0)
    v_log_f32 v148, v148
    v_mul_f32 v144, s69, v144
    v_mov_b32 v75, s70
    v_log_f32 v149, v149
    v_mul_f32 v145, s69, v145
    v_mov_b32 v79, s70
    v_log_f32 v150, v150
    v_mul_f32 v146, s69, v146
    v_mov_b32 v83, s70
    v_log_f32 v151, v151
    v_mul_f32 v147, s69, v147
    v_mov_b32 v87, s70
    v_add_f32 v74, v144, v148
    v_add_f32 v78, v145, v149
    v_add_f32 v82, v146, v150
    v_add_f32 v86, v147, v151
    s_waitcnt vmcnt(0) lgkmcnt(0)
    v_perm_b32 v152, v108, v104, s56
    v_perm_b32 v153, v116, v112, s56
    v_perm_b32 v154, v124, v120, s56
    v_perm_b32 v155, v132, v128, s56
    v_perm_b32 v156, v108, v104, s57
    v_perm_b32 v157, v116, v112, s57
    v_perm_b32 v158, v124, v120, s57
    v_perm_b32 v159, v132, v128, s57
    v_mfma_f32_16x16x32_bf16 v[160:163], v[40:43], v[152:155], v[160:163]
    v_perm_b32 v144, v109, v105, s56
    v_perm_b32 v145, v117, v113, s56
    v_perm_b32 v146, v125, v121, s56
    v_perm_b32 v147, v133, v129, s56
    v_mfma_f32_16x16x32_bf16 v[164:167], v[40:43], v[156:159], v[164:167]
    v_perm_b32 v152, v109, v105, s57
    v_perm_b32 v153, v117, v113, s57
    v_perm_b32 v154, v125, v121, s57
    v_perm_b32 v155, v133, v129, s57
    v_mfma_f32_16x16x32_bf16 v[160:163], v[44:47], v[144:147], v[160:163]
    v_perm_b32 v156, v110, v106, s56
    v_perm_b32 v157, v118, v114, s56
    v_perm_b32 v158, v126, v122, s56
    v_perm_b32 v159, v134, v130, s56
    v_mfma_f32_16x16x32_bf16 v[164:167], v[44:47], v[152:155], v[164:167]
    v_perm_b32 v144, v110, v106, s57
    v_perm_b32 v145, v118, v114, s57
    v_perm_b32 v146, v126, v122, s57
    v_perm_b32 v147, v134, v130, s57
    v_mfma_f32_16x16x32_bf16 v[160:163], v[48:51], v[156:159], v[160:163]
    v_perm_b32 v152, v111, v107, s56
    v_perm_b32 v153, v119, v115, s56
    v_perm_b32 v154, v127, v123, s56
    v_perm_b32 v155, v135, v131, s56
    v_mfma_f32_16x16x32_bf16 v[164:167], v[48:51], v[144:147], v[164:167]
    v_perm_b32 v156, v111, v107, s57
    v_perm_b32 v157, v119, v115, s57
    v_perm_b32 v158, v127, v123, s57
    v_perm_b32 v159, v135, v131, s57
    v_mfma_f32_16x16x32_bf16 v[160:163], v[52:55], v[152:155], v[160:163]
    s_nop 0
    v_mfma_f32_16x16x32_bf16 v[164:167], v[52:55], v[156:159], v[164:167]
    s_cmp_eq_u32 s47, 1
    s_cbranch_scc1 L_vB
    s_nop 5
    ds_write_b128 v137, v[160:163]
    ds_write_b128 v137, v[164:167] offset:1024
    s_mov_b64 exec, 1
    ds_add_rtn_u32 v143, v3, v139 offset:112
    s_mov_b64 exec, -1
    ds_read_b128 v[8:11], v136 offset:13312
    ds_read_b128 v[12:15], v136 offset:14336
    ds_read_b128 v[16:19], v136 offset:15360
    ds_read_b128 v[20:23], v136 offset:16384
    ds_read_b128 v[24:27], v136 offset:17408
    ds_read_b128 v[28:31], v136 offset:18432
    ds_read_b128 v[32:35], v136 offset:19456
    ds_read_b128 v[36:39], v136 offset:20480
    ds_read_b128 v[40:43], v136 offset:1280
    ds_read_b128 v[44:47], v136 offset:2304
    s_waitcnt lgkmcnt(2)
    v_readfirstlane_b32 s72, v143
    v_add_f32 v8, v8, v16
    v_add_f32 v24, v24, v32
    v_add_f32 v9, v9, v17
    v_add_f32 v25, v25, v33
    v_add_f32 v10, v10, v18
    v_add_f32 v26, v26, v34
    v_add_f32 v11, v11, v19
    v_add_f32 v27, v27, v35
    v_add_f32 v12, v12, v20
    v_add_f32 v28, v28, v36
    v_add_f32 v13, v13, v21
    v_add_f32 v29, v29, v37
    v_add_f32 v14, v14, v22
    v_add_f32 v30, v30, v38
    v_add_f32 v15, v15, v23
    v_add_f32 v31, v31, v39
    s_cmp_lg_u32 s72, s71
    s_cbranch_scc1 L_team
    s_waitcnt lgkmcnt(0)
    v_add_f32 v8, v8, v40
    v_add_f32 v72, v8, v24
    v_add_f32 v12, v12, v44
    v_add_f32 v73, v12, v28
    buffer_store_dwordx4 v[72:75], v141, s[40:43], s60 offen sc1
    v_add_f32 v9, v9, v41
    v_add_f32 v76, v9, v25
    v_add_f32 v13, v13, v45
    v_add_f32 v77, v13, v29
    buffer_store_dwordx4 v[76:79], v141, s[40:43], s61 offen sc1
    v_add_f32 v10, v10, v42
    v_add_f32 v80, v10, v26
    v_add_f32 v14, v14, v46
    v_add_f32 v81, v14, v30
    buffer_store_dwordx4 v[80:83], v141, s[40:43], s62 offen sc1
    v_add_f32 v11, v11, v43
    v_add_f32 v84, v11, v27
    v_add_f32 v15, v15, v47
    v_add_f32 v85, v15, v31
    buffer_store_dwordx4 v[84:87], v141, s[40:43], s63 offen sc1
    s_branch L_team
L_vB:
    s_nop 5
    v_mov_b32 v72, v160
    v_mov_b32 v73, v164
    buffer_store_dwordx4 v[72:75], v141, s[40:43], s60 offen sc1
    v_mov_b32 v76, v161
    v_mov_b32 v77, v165
    buffer_store_dwordx4 v[76:79], v141, s[40:43], s61 offen sc1
    v_mov_b32 v80, v162
    v_mov_b32 v81, v166
    buffer_store_dwordx4 v[80:83], v141, s[40:43], s62 offen sc1
    v_mov_b32 v84, v163
    v_mov_b32 v85, v167
    buffer_store_dwordx4 v[84:87], v141, s[40:43], s63 offen sc1
    s_branch L_fin
L_service2:
    s_load_dwordx2 s[30:31], s[28:29], 0x100
    s_mov_b32 s40, s28
    s_mov_b32 s41, s29
    s_mov_b32 s42, 0x10000000
    s_mov_b32 s43, 0x00020000
    s_mov_b32 s64, 0x3030303
    s_mov_b32 s65, 0x3030303
    s_mov_b32 s66, 0xc0c0c0c
    s_mov_b32 s67, 0xc0c0c0c
    s_mov_b32 s68, 0x30303030
    s_mov_b32 s69, 0x30303030
    s_mov_b32 s70, 0xc0c0c0c0
    s_mov_b32 s71, 0xc0c0c0c0
    v_and_b32 v4, 7, v2
    v_lshlrev_b32 v4, 5, v4
    v_and_b32 v5, 1, v6
    v_lshl_add_u32 v4, v5, 4, v4
    v_lshrrev_b32 v5, 5, v2
    v_lshl_add_u32 v4, v5, 9, v4
    s_lshl_b32 s72, s3, 10
    v_add_u32 v4, s72, v4
    v_mov_b32 v5, 1
    v_lshlrev_b32 v7, 3, v2
    v_and_b32 v144, 31, v2
    v_lshlrev_b32 v144, 4, v144
    v_lshrrev_b32 v145, 5, v2
    v_lshl_add_u32 v144, v145, 16, v144
    s_lshl_b32 s62, s52, 17
    s_lshl_b32 s63, s53, 15
    s_add_u32 s62, s62, s63
    s_lshl_b32 s63, s54, 9
    s_add_u32 s62, s62, s63
    s_add_u32 s62, s62, 0x10000
    s_waitcnt vmcnt(16)
    v_cndmask_b32 v72, 0, v136, s[64:65]
    v_cndmask_b32 v73, 0, v137, s[64:65]
    v_cndmask_b32 v74, 0, v138, s[64:65]
    v_cndmask_b32 v75, 0, v139, s[64:65]
    v_cndmask_b32 v88, 0, v140, s[64:65]
    v_cndmask_b32 v89, 0, v141, s[64:65]
    v_cndmask_b32 v90, 0, v142, s[64:65]
    v_cndmask_b32 v91, 0, v143, s[64:65]
    v_cndmask_b32 v76, 0, v136, s[66:67]
    v_cndmask_b32 v77, 0, v137, s[66:67]
    v_cndmask_b32 v78, 0, v138, s[66:67]
    v_cndmask_b32 v79, 0, v139, s[66:67]
    v_cndmask_b32 v92, 0, v140, s[66:67]
    v_cndmask_b32 v93, 0, v141, s[66:67]
    v_cndmask_b32 v94, 0, v142, s[66:67]
    v_cndmask_b32 v95, 0, v143, s[66:67]
    v_cndmask_b32 v80, 0, v136, s[68:69]
    v_cndmask_b32 v81, 0, v137, s[68:69]
    v_cndmask_b32 v82, 0, v138, s[68:69]
    v_cndmask_b32 v83, 0, v139, s[68:69]
    v_cndmask_b32 v96, 0, v140, s[68:69]
    v_cndmask_b32 v97, 0, v141, s[68:69]
    v_cndmask_b32 v98, 0, v142, s[68:69]
    v_cndmask_b32 v99, 0, v143, s[68:69]
    v_cndmask_b32 v84, 0, v136, s[70:71]
    v_cndmask_b32 v85, 0, v137, s[70:71]
    v_cndmask_b32 v86, 0, v138, s[70:71]
    v_cndmask_b32 v87, 0, v139, s[70:71]
    v_cndmask_b32 v100, 0, v140, s[70:71]
    v_cndmask_b32 v101, 0, v141, s[70:71]
    v_cndmask_b32 v102, 0, v142, s[70:71]
    v_cndmask_b32 v103, 0, v143, s[70:71]
    s_waitcnt vmcnt(8)
    v_perm_b32 v152, v12, v8, s56
    v_perm_b32 v153, v20, v16, s56
    v_perm_b32 v154, v28, v24, s56
    v_perm_b32 v155, v36, v32, s56
    s_nop 1
    v_mfma_f32_16x16x32_bf16 v[160:163], v[72:75], v[152:155], 0
    v_perm_b32 v156, v12, v8, s57
    v_perm_b32 v157, v20, v16, s57
    v_perm_b32 v158, v28, v24, s57
    v_perm_b32 v159, v36, v32, s57
    s_nop 1
    v_mfma_f32_16x16x32_bf16 v[164:167], v[72:75], v[156:159], 0
    v_perm_b32 v152, v13, v9, s56
    v_perm_b32 v153, v21, v17, s56
    v_perm_b32 v154, v29, v25, s56
    v_perm_b32 v155, v37, v33, s56
    s_nop 1
    v_mfma_f32_16x16x32_bf16 v[160:163], v[76:79], v[152:155], v[160:163]
    v_perm_b32 v156, v13, v9, s57
    v_perm_b32 v157, v21, v17, s57
    v_perm_b32 v158, v29, v25, s57
    v_perm_b32 v159, v37, v33, s57
    s_nop 1
    v_mfma_f32_16x16x32_bf16 v[164:167], v[76:79], v[156:159], v[164:167]
    v_perm_b32 v152, v14, v10, s56
    v_perm_b32 v153, v22, v18, s56
    v_perm_b32 v154, v30, v26, s56
    v_perm_b32 v155, v38, v34, s56
    s_nop 1
    v_mfma_f32_16x16x32_bf16 v[160:163], v[80:83], v[152:155], v[160:163]
    v_perm_b32 v156, v14, v10, s57
    v_perm_b32 v157, v22, v18, s57
    v_perm_b32 v158, v30, v26, s57
    v_perm_b32 v159, v38, v34, s57
    s_nop 1
    v_mfma_f32_16x16x32_bf16 v[164:167], v[80:83], v[156:159], v[164:167]
    v_perm_b32 v152, v15, v11, s56
    v_perm_b32 v153, v23, v19, s56
    v_perm_b32 v154, v31, v27, s56
    v_perm_b32 v155, v39, v35, s56
    s_nop 1
    v_mfma_f32_16x16x32_bf16 v[160:163], v[84:87], v[152:155], v[160:163]
    v_perm_b32 v156, v15, v11, s57
    v_perm_b32 v157, v23, v19, s57
    v_perm_b32 v158, v31, v27, s57
    v_perm_b32 v159, v39, v35, s57
    s_nop 1
    v_mfma_f32_16x16x32_bf16 v[164:167], v[84:87], v[156:159], v[164:167]
    s_waitcnt vmcnt(0)
    v_perm_b32 v152, v44, v40, s56
    v_perm_b32 v153, v52, v48, s56
    v_perm_b32 v154, v60, v56, s56
    v_perm_b32 v155, v68, v64, s56
    s_nop 1
    v_mfma_f32_16x16x32_bf16 v[160:163], v[88:91], v[152:155], v[160:163]
    v_perm_b32 v156, v44, v40, s57
    v_perm_b32 v157, v52, v48, s57
    v_perm_b32 v158, v60, v56, s57
    v_perm_b32 v159, v68, v64, s57
    s_nop 1
    v_mfma_f32_16x16x32_bf16 v[164:167], v[88:91], v[156:159], v[164:167]
    v_perm_b32 v152, v45, v41, s56
    v_perm_b32 v153, v53, v49, s56
    v_perm_b32 v154, v61, v57, s56
    v_perm_b32 v155, v69, v65, s56
    s_nop 1
    v_mfma_f32_16x16x32_bf16 v[160:163], v[92:95], v[152:155], v[160:163]
    v_perm_b32 v156, v45, v41, s57
    v_perm_b32 v157, v53, v49, s57
    v_perm_b32 v158, v61, v57, s57
    v_perm_b32 v159, v69, v65, s57
    s_nop 1
    v_mfma_f32_16x16x32_bf16 v[164:167], v[92:95], v[156:159], v[164:167]
    v_perm_b32 v152, v46, v42, s56
    v_perm_b32 v153, v54, v50, s56
    v_perm_b32 v154, v62, v58, s56
    v_perm_b32 v155, v70, v66, s56
    s_nop 1
    v_mfma_f32_16x16x32_bf16 v[160:163], v[96:99], v[152:155], v[160:163]
    v_perm_b32 v156, v46, v42, s57
    v_perm_b32 v157, v54, v50, s57
    v_perm_b32 v158, v62, v58, s57
    v_perm_b32 v159, v70, v66, s57
    s_nop 1
    v_mfma_f32_16x16x32_bf16 v[164:167], v[96:99], v[156:159], v[164:167]
    v_perm_b32 v152, v47, v43, s56
    v_perm_b32 v153, v55, v51, s56
    v_perm_b32 v154, v63, v59, s56
    v_perm_b32 v155, v71, v67, s56
    s_nop 1
    v_mfma_f32_16x16x32_bf16 v[160:163], v[100:103], v[152:155], v[160:163]
    v_perm_b32 v156, v47, v43, s57
    v_perm_b32 v157, v55, v51, s57
    v_perm_b32 v158, v63, v59, s57
    v_perm_b32 v159, v71, v67, s57
    s_nop 1
    v_mfma_f32_16x16x32_bf16 v[164:167], v[100:103], v[156:159], v[164:167]
    s_nop 7
    v_mov_b32 v16, v160
    v_mov_b32 v17, v164
    v_mov_b32 v18, v162
    v_mov_b32 v19, v166
    v_mov_b32 v20, v161
    v_mov_b32 v21, v165
    v_mov_b32 v22, v163
    v_mov_b32 v23, v167
    s_mov_b32 exec_lo, 0xff00ff
    s_mov_b32 exec_hi, 0xff00ff00
    ds_write_b128 v4, v[16:19] offset:4096
    ds_write_b128 v4, v[20:23] offset:4352
    s_waitcnt lgkmcnt(0)
    s_mov_b64 exec, 1
    ds_add_rtn_u32 v14, v3, v5 offset:64
    s_mov_b64 exec, -1
    ds_read_b64 v[24:25], v7 offset:4096
    ds_read_b64 v[26:27], v7 offset:4608
    ds_read_b64 v[28:29], v7 offset:5120
    ds_read_b64 v[30:31], v7 offset:5632
    s_add_u32 s30, s30, 0x9e3779b9
    s_add_u32 s31, s31, 0x9e3779b9
    s_cmp_eq_u32 s52, 1
    s_cselect_b32 s60, s31, s30
    v_mov_b32 v9, s60
    v_mov_b32 v11, s60
    v_mov_b32 v12, s30
    v_mov_b32 v13, s31
    s_waitcnt lgkmcnt(0)
    v_readfirstlane_b32 s61, v14
    v_add_f32 v8, v24, v26
    v_add_f32 v10, v25, v27
    v_add_f32 v24, v28, v30
    v_add_f32 v25, v29, v31
    v_add_f32 v8, v8, v24
    v_add_f32 v10, v10, v25
    s_cmp_lg_u32 s61, 1
    s_cbranch_scc1 L_noqpub
    buffer_store_dwordx4 v[8:11], v144, s[40:43], s62 offen sc1
    s_mov_b64 exec, 1
    ds_write_b64 v3, v[12:13] offset:160
    ds_write_b32 v3, v5 offset:124
    s_mov_b64 exec, -1
L_noqpub:
    s_cmp_eq_u32 s3, 1
    s_cselect_b32 s50, s31, s30
    s_lshr_b32 s60, s49, 3
    s_and_b32 s61, s49, 7
    s_lshl_b32 s62, s3, 1
    s_add_u32 s62, s62, s60
    s_lshl_b32 s62, s62, 16
    s_lshl_b32 s63, s61, 12
    s_add_u32 s62, s62, s63
    s_add_u32 s62, s62, 0x10000
    s_add_u32 s63, s62, 32768
    s_cmp_le_u32 s48, 12
    s_cselect_b32 s60, 1, 0
    s_cmp_ge_u32 s48, 12
    s_cselect_b32 s61, 1, 0
    s_cmp_eq_u32 s3, 1
    s_cselect_b32 s60, s61, s60
    s_cmp_eq_u32 s60, 1
    s_cbranch_scc1 L_qneed
    s_mov_b64 exec, 1
    v_mov_b32 v5, 1
    ds_add_u32 v3, v5 offset:120
    s_mov_b64 exec, -1
    s_branch L_qdone
L_qneed:
    s_mov_b32 s58, 0
sg_q_26:
    s_load_dword s64, s[28:29], s62 offset:4 glc
    s_load_dword s65, s[28:29], s62 offset:516 glc
    s_load_dword s66, s[28:29], s62 offset:1028 glc
    s_load_dword s67, s[28:29], s62 offset:1540 glc
    s_load_dword s68, s[28:29], s62 offset:2052 glc
    s_load_dword s69, s[28:29], s62 offset:2564 glc
    s_load_dword s70, s[28:29], s62 offset:3076 glc
    s_load_dword s71, s[28:29], s62 offset:3588 glc
    s_load_dword s32, s[28:29], s63 offset:4 glc
    s_load_dword s33, s[28:29], s63 offset:516 glc
    s_load_dword s34, s[28:29], s63 offset:1028 glc
    s_load_dword s35, s[28:29], s63 offset:1540 glc
    s_load_dword s36, s[28:29], s63 offset:2052 glc
    s_load_dword s37, s[28:29], s63 offset:2564 glc
    s_load_dword s38, s[28:29], s63 offset:3076 glc
    s_load_dword s39, s[28:29], s63 offset:3588 glc
    s_add_u32 s58, s58, 1
    s_mov_b32 s59, 0
    s_waitcnt lgkmcnt(0)
    s_cmp_eq_u32 s64, s50
    s_addc_u32 s59, s59, 0
    s_cmp_eq_u32 s65, s50
    s_addc_u32 s59, s59, 0
    s_cmp_eq_u32 s66, s50
    s_addc_u32 s59, s59, 0
    s_cmp_eq_u32 s67, s50
    s_addc_u32 s59, s59, 0
    s_cmp_eq_u32 s68, s50
    s_addc_u32 s59, s59, 0
    s_cmp_eq_u32 s69, s50
    s_addc_u32 s59, s59, 0
    s_cmp_eq_u32 s70, s50
    s_addc_u32 s59, s59, 0
    s_cmp_eq_u32 s71, s50
    s_addc_u32 s59, s59, 0
    s_cmp_eq_u32 s32, s50
    s_addc_u32 s59, s59, 0
    s_cmp_eq_u32 s33, s50
    s_addc_u32 s59, s59, 0
    s_cmp_eq_u32 s34, s50
    s_addc_u32 s59, s59, 0
    s_cmp_eq_u32 s35, s50
    s_addc_u32 s59, s59, 0
    s_cmp_eq_u32 s36, s50
    s_addc_u32 s59, s59, 0
    s_cmp_eq_u32 s37, s50
    s_addc_u32 s59, s59, 0
    s_cmp_eq_u32 s38, s50
    s_addc_u32 s59, s59, 0
    s_cmp_eq_u32 s39, s50
    s_addc_u32 s59, s59, 0
    s_cmp_ge_u32 s58, 65536
    s_cbranch_scc1 sgd_q_27
    s_cmp_ge_u32 s59, 16
    s_cbranch_scc1 sgd_q_27
    s_sleep 2
    s_branch sg_q_26
sgd_q_27:
    v_lshlrev_b32 v4, 4, v2
    s_mov_b32 s58, 0
    buffer_load_dwordx4 v[16:19], v4, s[40:43], s62 offen offset:0 sc1
    buffer_load_dwordx4 v[20:23], v4, s[40:43], s62 offen offset:1024 sc1
    buffer_load_dwordx4 v[24:27], v4, s[40:43], s62 offen offset:2048 sc1
    buffer_load_dwordx4 v[28:31], v4, s[40:43], s62 offen offset:3072 sc1
    buffer_load_dwordx4 v[32:35], v4, s[40:43], s63 offen offset:0 sc1
    buffer_load_dwordx4 v[36:39], v4, s[40:43], s63 offen offset:1024 sc1
    buffer_load_dwordx4 v[40:43], v4, s[40:43], s63 offen offset:2048 sc1
    buffer_load_dwordx4 v[44:47], v4, s[40:43], s63 offen offset:3072 sc1
    s_mov_b64 exec, 1
    v_mov_b32 v5, 1
    ds_add_u32 v3, v5 offset:120
    s_mov_b64 exec, -1
    s_branch pchk_q_30
poll_q_28:
    s_mov_b64 exec, s[32:33]
    s_cbranch_execz skip_31
    buffer_load_dwordx4 v[16:19], v4, s[40:43], s62 offen offset:0 sc1
    buffer_load_dwordx4 v[20:23], v4, s[40:43], s62 offen offset:1024 sc1
    buffer_load_dwordx4 v[24:27], v4, s[40:43], s62 offen offset:2048 sc1
    buffer_load_dwordx4 v[28:31], v4, s[40:43], s62 offen offset:3072 sc1
skip_31:
    s_mov_b64 exec, s[34:35]
    s_cbranch_execz skip_32
    buffer_load_dwordx4 v[32:35], v4, s[40:43], s63 offen offset:0 sc1
    buffer_load_dwordx4 v[36:39], v4, s[40:43], s63 offen offset:1024 sc1
    buffer_load_dwordx4 v[40:43], v4, s[40:43], s63 offen offset:2048 sc1
    buffer_load_dwordx4 v[44:47], v4, s[40:43], s63 offen offset:3072 sc1
skip_32:
    s_mov_b64 exec, -1
pchk_q_30:
    s_add_u32 s58, s58, 1
    s_waitcnt vmcnt(0)
    v_max3_u32 v5, v17, v19, v21
    v_min3_u32 v6, v17, v19, v21
    v_max3_u32 v5, v5, v23, v25
    v_min3_u32 v6, v6, v23, v25
    v_max3_u32 v5, v5, v27, v29
    v_min3_u32 v6, v6, v27, v29
    v_max_u32 v5, v5, v31
    v_min_u32 v6, v6, v31
    v_xor_b32 v5, s50, v5
    v_xor_b32 v6, s50, v6
    v_or_b32 v5, v5, v6
    v_cmp_ne_u32 s[32:33], 0, v5
    v_max3_u32 v5, v33, v35, v37
    v_min3_u32 v6, v33, v35, v37
    v_max3_u32 v5, v5, v39, v41
    v_min3_u32 v6, v6, v39, v41
    v_max3_u32 v5, v5, v43, v45
    v_min3_u32 v6, v6, v43, v45
    v_max_u32 v5, v5, v47
    v_min_u32 v6, v6, v47
    v_xor_b32 v5, s50, v5
    v_xor_b32 v6, s50, v6
    v_or_b32 v5, v5, v6
    v_cmp_ne_u32 s[34:35], 0, v5
    s_cmp_ge_u32 s58, 65536
    s_cbranch_scc1 polled_q_29
    s_bcnt1_i32_b64 s59, s[32:33]
    s_bcnt1_i32_b64 s51, s[34:35]
    s_add_u32 s59, s59, s51
    s_cmp_eq_u32 s59, 0
    s_cbranch_scc1 polled_q_29
    s_cmp_le_u32 s59, 0
    s_cbranch_scc1 poll_q_28
    s_sleep 2
    s_branch poll_q_28
polled_q_29:
    v_lshlrev_b32 v4, 2, v2
    s_lshl_b32 s60, s3, 10
    v_add_u32 v4, s60, v4
    v_add_f32 v16, v16, v32
    v_add_f32 v18, v18, v34
    v_cvt_pk_bf16_f32 v16, v16, v18
    ds_write_b32 v4, v16 offset:6144
    v_add_f32 v20, v20, v36
    v_add_f32 v22, v22, v38
    v_cvt_pk_bf16_f32 v20, v20, v22
    ds_write_b32 v4, v20 offset:6400
    v_add_f32 v24, v24, v40
    v_add_f32 v26, v26, v42
    v_cvt_pk_bf16_f32 v24, v24, v26
    ds_write_b32 v4, v24 offset:6656
    v_add_f32 v28, v28, v44
    v_add_f32 v30, v30, v46
    v_cvt_pk_bf16_f32 v28, v28, v30
    ds_write_b32 v4, v28 offset:6912
    s_lshl_b32 s60, s3, 2
    v_mov_b32 v7, s60
    v_mov_b32 v5, 1
    ds_write_b32 v7, v5 offset:68
L_qdone:
    s_lshr_b32 s55, s2, 7
    s_cmp_eq_u32 s55, 1
    s_cselect_b32 s50, s31, s30
    s_lshl_b32 s60, s55, 2
    v_mov_b32 v7, s60
    s_mul_i32 s68, s55, 266240
    s_and_b32 s74, s2, 7
    s_lshl_b32 s74, s74, 5
    s_bfe_u32 s75, s2, 0x40003
    s_lshl_b32 s75, s75, 1
    s_add_u32 s74, s74, s75
    s_add_u32 s74, s74, s3
    s_lshl_b32 s70, s74, 5
    s_add_u32 s70, s70, s68
    s_add_u32 s70, s70, 0x400000
    s_mov_b32 s72, 8320
    v_lshrrev_b32 v139, 1, v2
    v_mul_lo_u32 v139, s72, v139
    v_and_b32 v141, 1, v2
    v_lshl_add_u32 v139, v141, 4, v139
    s_lshl_b32 s72, s74, 2
    s_lshl_b32 s73, s55, 10
    s_add_u32 s72, s72, s73
    v_lshrrev_b32 v140, 5, v2
    v_lshlrev_b32 v140, 11, v140
    s_mov_b32 s44, s24
    s_mov_b32 s45, s25
    s_mov_b32 s46, 0x1000
    s_mov_b32 s47, 0x00020000
    s_mov_b32 s58, 0
spin_op_33:
    ds_read_b32 v1, v3 offset:140
    s_waitcnt lgkmcnt(0)
    v_readfirstlane_b32 s59, v1
    s_add_u32 s58, s58, 1
    s_cmp_ge_u32 s58, 1048576
    s_cbranch_scc1 spun_op_34
    s_cmp_ge_u32 s59, 1
    s_cbranch_scc1 spun_op_34
    s_sleep 2
    s_branch spin_op_33
spun_op_34:
    s_mov_b32 s58, 0
    buffer_load_dwordx4 v[8:11], v139, s[40:43], s70 offen sc1
    s_branch pchk_h3_37
poll_h3_35:
    s_mov_b64 exec, s[32:33]
    s_cbranch_execz skip_38
    buffer_load_dwordx4 v[8:11], v139, s[40:43], s70 offen sc1
skip_38:
    s_mov_b64 exec, -1
pchk_h3_37:
    s_add_u32 s58, s58, 1
    s_waitcnt vmcnt(0)
    v_xor_b32 v5, s50, v9
    v_xor_b32 v4, s50, v11
    v_or_b32 v5, v5, v4
    v_cmp_ne_u32 s[32:33], 0, v5
    s_cmp_ge_u32 s58, 65536
    s_cbranch_scc1 polled_h3_36
    s_bcnt1_i32_b64 s59, s[32:33]
    s_cmp_eq_u32 s59, 0
    s_cbranch_scc1 polled_h3_36
    s_cmp_le_u32 s59, 32
    s_cbranch_scc1 poll_h3_35
    s_sleep 2
    s_branch poll_h3_35
polled_h3_36:
    s_nop 1
    v_permlane32_swap_b32 v8, v10
    s_nop 1
    v_add_f32 v8, v8, v10
    s_nop 0
    v_mov_b32 v10, v8
    s_nop 1
    v_permlane16_swap_b32 v8, v10
    s_nop 1
    v_add_f32 v8, v8, v10
    s_nop 1
    v_add_f32_dpp v8, v8, v8 row_ror:8 row_mask:0xf bank_mask:0xf
    s_nop 1
    v_add_f32_dpp v8, v8, v8 row_ror:4 row_mask:0xf bank_mask:0xf
    s_nop 1
    v_add_f32_dpp v8, v8, v8 row_ror:2 row_mask:0xf bank_mask:0xf
    s_nop 1
    v_mov_b32_dpp v10, v8 quad_perm:[1,1,3,3] row_mask:0xf bank_mask:0xf
    v_cvt_pk_bf16_f32 v8, v8, v10
    s_mov_b32 exec_lo, 0x1
    s_mov_b32 exec_hi, 0x1
    buffer_store_dword v8, v140, s[44:47], s72 offen
    s_and_b32 s60, s2, 127
    s_or_b32 s60, s60, s3
    s_cmp_lg_u32 s60, 0
    s_cbranch_scc1 L_noep
    s_mov_b64 exec, 1
    v_mov_b32 v5, s50
    buffer_store_dword v5, v7, s[40:43], 0 offen offset:256 sc1
L_noep:
    s_mov_b64 exec, -1
L_fin:
L_end:
    s_endpgm
.section .rodata,"a"
.p2align 6
.amdhsa_kernel concat_heads__gqa_block_cached__sliding_block_cached__decode_kernel
  .amdhsa_next_free_vgpr 168
  .amdhsa_next_free_sgpr 102
  .amdhsa_accum_offset 168
  .amdhsa_group_segment_fixed_size 0
  .amdhsa_kernarg_size 104
  .amdhsa_user_sgpr_count 2
  .amdhsa_user_sgpr_kernarg_segment_ptr 1
  .amdhsa_system_sgpr_workgroup_id_x 1
  .amdhsa_float_denorm_mode_32 3
.end_amdhsa_kernel
```
